```python
import torch

def _softmax(x, axis=-1):
    return torch.softmax(x, dim=axis)
def _gelu(x):
    return torch.nn.functional.gelu(x, approximate="tanh")
def _silu(x):
    return torch.nn.functional.silu(x)
def _sigmoid(x):
    return torch.sigmoid(x)
def _layernorm(x, axis=-1, eps=1e-5):
    m = x.mean(dim=axis, keepdim=True)
    v = x.var(dim=axis, keepdim=True, unbiased=False)
    return (x - m) / torch.sqrt(v + eps)
def _scatter_add(tgt, idx, src, axis=0):
    return tgt.clone().index_add_(axis, idx, src)
def _segment_sum(src, seg, n):
    out = torch.zeros((n,) + src.shape[1:], dtype=src.dtype)
    return out.index_add_(0, seg, src)
def _pad(x, pw):
    flat = tuple(v for pair in reversed(pw) for v in pair)
    return torch.nn.functional.pad(x, flat)

kernel_name = 'sequential_preLN__linear_kernel_hedgehog__dense_activation_mish__prompt'

def setup_inputs():

    _w = (lambda a: (lambda t: t.to(torch.bfloat16) if t.is_floating_point() else t)(torch.as_tensor(a)))
    def _A_setup():
        B, S, D, H = 1, 2048, 448, 16
        Dh = D // H
        return {
            "x": _w((lambda *s: torch.randn(*s, dtype=torch.bfloat16) * 0.05)(B, S, D)),
            "wqkv": _w((lambda *s: torch.randn(*s, dtype=torch.bfloat16) * 0.2)(D, 3 * D)),
            "w_phi": _w((lambda *s: torch.randn(*s, dtype=torch.bfloat16) * 0.2)(H, Dh, Dh) * (Dh ** -0.5)),
            "wo": _w((lambda *s: torch.randn(*s, dtype=torch.bfloat16) * 0.05)(D, D)),
        }
    _A_in = _A_setup()

    def _B_setup():
        B, S, D, F = 1, 2048, 448, 1792
        return {
            "x": _w((lambda *s: torch.randn(*s, dtype=torch.bfloat16) * 0.05)(B, S, D)),
            "w1": _w((lambda *s: torch.randn(*s, dtype=torch.bfloat16) * 1.6)(D, F) * (D ** -0.5)),
            "b1": _w((lambda *s: torch.randn(*s, dtype=torch.bfloat16) * 0.4)(F)),
            "w2": _w((lambda *s: torch.randn(*s, dtype=torch.bfloat16) * 0.1)(F, D) * (F ** -0.5)),
        }
    _B_in = _B_setup()

    return {
        "A_x": _A_in["x"],
        "A_wqkv": _A_in["wqkv"],
        "A_w_phi": _A_in["w_phi"],
        "A_wo": _A_in["wo"],
        "B_x": _B_in["x"],
        "B_w1": _B_in["w1"],
        "B_b1": _B_in["b1"],
        "B_w2": _B_in["w2"],
    }

def reference(A_x, A_wqkv, A_w_phi, A_wo, B_x, B_w1, B_b1, B_w2):
    def _A_ref(x, wqkv, w_phi, wo):
        B, S, D = x.shape
        H = 16; Dh = D // H
        qkv = (lambda x, *d: x.permute(*d))((x @ wqkv).reshape(B, S, 3, H, Dh), 2, 0, 3, 1, 4)
        q, k, v = qkv[0], qkv[1], qkv[2]
        pq = torch.einsum("bhsd,hdf->bhsf", q, w_phi)
        pk = torch.einsum("bhsd,hdf->bhsf", k, w_phi)
        phi_q = torch.concatenate([_softmax(pq, axis=-1), _softmax(-pq, axis=-1)], axis=-1)
        phi_k = torch.concatenate([_softmax(pk, axis=-1), _softmax(-pk, axis=-1)], axis=-1)
        kv = torch.einsum("bhsf,bhsd->bhfd", phi_k, v)
        z  = torch.einsum("bhsf->bhf", phi_k)
        num = torch.einsum("bhqf,bhfd->bhqd", phi_q, kv)
        den = torch.einsum("bhqf,bhf->bhq", phi_q, z)[..., None] + 1e-6
        o = num / den
        return (lambda x, *d: x.permute(*d))(o, 0, 2, 1, 3).reshape(B, S, D) @ wo

    def _B_ref(x, w1, b1, w2):
        h = torch.einsum("bsd,df->bsf", x, w1) + b1
        sp = torch.log1p(torch.exp(-torch.abs(h))) + torch.where(h > 0, h, torch.zeros_like(h))
        act = h * torch.tanh(sp)
        return torch.einsum("bsf,fd->bsd", act, w2)

    x = A_x
    h = x + _A_ref(_layernorm(x, axis=-1), A_wqkv, A_w_phi, A_wo)
    h2 = h + _B_ref(_layernorm(h, axis=-1), B_w1, B_b1, B_w2)
    return h2
```

```asm
; @launch grid=(256,1,1) block=(512,1,1) lds=163840
.amdgcn_target "amdgcn-amd-amdhsa--gfx950"
.text
.globl sequential_preLN__linear_kernel_hedgehog__dense_activation_mish__prompt_kernel
.p2align 8
.type sequential_preLN__linear_kernel_hedgehog__dense_activation_mish__prompt_kernel,@function
sequential_preLN__linear_kernel_hedgehog__dense_activation_mish__prompt_kernel:
L_start:
    s_cmp_ge_u32 s2, 256
    s_cbranch_scc1 L_end
    s_load_dwordx2 s[8:9], s[0:1], 0
    s_load_dwordx2 s[12:13], s[0:1], 8
    s_load_dwordx2 s[40:41], s[0:1], 80
    s_load_dwordx2 s[16:17], s[0:1], 16
    v_and_b32 v1, 63, v0
    v_readfirstlane_b32 s4, v0
    s_getpc_b64 s[62:63]
L_pc:
    s_lshr_b32 s60, s2, 3
    v_lshrrev_b32 v4, 5, v0
    v_lshl_add_u32 v4, v4, 5, s60
    v_lshlrev_b32 v4, 7, v4
    v_min_u32 v4, L_end-L_pc, v4
    global_load_dword v255, v4, s[62:63]
    s_mov_b32 s10, 1835008
    s_mov_b32 s11, 0x20000
    s_mov_b32 s14, 1204224
    s_mov_b32 s15, 0x20000
    s_lshr_b32 s4, s4, 6
    s_and_b32 s47, s4, 3
    s_bfe_u32 s60, s2, 0x30003
    s_and_b32 s61, s2, 1
    s_lshl_b32 s46, s61, 3
    s_add_u32 s46, s46, s60
    s_lshr_b32 s64, s2, 6
    s_bfe_u32 s61, s2, 0x20001
    s_lshl_b32 s5, s61, 2
    s_add_u32 s5, s5, s64
    s_lshl_b32 s64, s64, 1
    s_add_u32 s66, s60, s64
    s_cmp_ge_u32 s66, 7
    s_cselect_b32 s61, 7, 0
    s_sub_u32 s66, s66, s61
    s_add_u32 s67, s66, 1
    s_cmp_eq_u32 s67, 7
    s_cselect_b32 s67, 0, s67
    s_mul_i32 s78, s46, 56
    s_cmp_eq_u32 s46, 15
    s_cselect_b32 s65, 8, 0
    s_sub_u32 s78, s78, s65
    s_mul_i32 s61, s47, 43008
    s_add_u32 s78, s78, s61
    s_lshl_b32 s77, s47, 10
    s_lshl_b32 s61, s5, 3
    s_add_u32 s61, s61, s4
    s_mul_i32 s51, s61, 14336
    s_lshl_b32 s76, s4, 11
    s_add_u32 s76, s76, 28672
    v_lshrrev_b32 v7, 3, v1
    v_mul_u32_u24 v7, 896, v7
    v_and_b32 v5, 7, v1
    v_lshrrev_b32 v6, 4, v1
    v_xor_b32 v5, v5, v6
    v_lshl_add_u32 v8, v5, 4, v7
    v_xor_b32 v5, 4, v5
    v_lshl_add_u32 v9, v5, 4, v7
    v_add_u32 v9, 7168, v9
    v_lshrrev_b32 v7, 2, v1
    v_mul_u32_u24 v7, 2688, v7
    v_and_b32 v5, 3, v1
    v_lshl_add_u32 v10, v5, 4, v7
    s_cmp_lt_u32 s4, 4
    s_cselect_b32 s60, s66, s67
    s_mul_i32 s60, s60, 172032
    s_add_u32 s60, s60, s78
    s_add_u32 s60, s60, 896
    s_lshl_b32 s61, s4, 10
    s_add_u32 m0, s61, 0
    s_waitcnt lgkmcnt(0)
    buffer_load_dwordx4 v10, s[12:15], s60 offen lds
    s_lshl_b32 s60, s66, 7
    s_add_u32 s60, s60, s51
    s_add_u32 m0, s76, 0
    s_nop 0
    buffer_load_dwordx4 v8, s[8:11], s60 offen lds
    s_add_u32 m0, s76, 1024
    s_nop 0
    buffer_load_dwordx4 v9, s[8:11], s60 offen lds
    s_load_dwordx2 s[20:21], s[0:1], 24
    s_load_dwordx2 s[24:25], s[0:1], 40
    s_load_dwordx2 s[28:29], s[0:1], 48
    s_load_dwordx2 s[32:33], s[0:1], 56
    s_load_dwordx2 s[36:37], s[0:1], 64
    s_add_u32 s68, s67, 1
    s_cmp_eq_u32 s68, 7
    s_cselect_b32 s68, 0, s68
    s_add_u32 s69, s68, 1
    s_cmp_eq_u32 s69, 7
    s_cselect_b32 s69, 0, s69
    s_add_u32 s70, s69, 1
    s_cmp_eq_u32 s70, 7
    s_cselect_b32 s70, 0, s70
    s_add_u32 s71, s70, 1
    s_cmp_eq_u32 s71, 7
    s_cselect_b32 s71, 0, s71
    s_add_u32 s72, s71, 1
    s_cmp_eq_u32 s72, 7
    s_cselect_b32 s72, 0, s72
    s_mov_b32 s18, 1568
    s_mov_b32 s19, 0x20000
    s_mov_b32 s22, 401408
    s_mov_b32 s23, 0x20000
    s_mov_b32 s26, 1605632
    s_mov_b32 s27, 0x20000
    s_mov_b32 s30, 3584
    s_mov_b32 s31, 0x20000
    s_mov_b32 s34, 1605632
    s_mov_b32 s35, 0x20000
    s_mov_b32 s38, 1835008
    s_mov_b32 s39, 0x20000
    s_mov_b32 s42, 16777216
    s_mov_b32 s43, 0x20000
    s_mov_b32 s73, 0x3f803f80
    s_mov_b32 s74, 0x00003f80
    s_mov_b32 s75, 0x3f800000
    v_mov_b32 v2, 161792
    v_mov_b32 v3, 1
    s_waitcnt lgkmcnt(0)
    s_lshl_b32 s60, s4, 21
    s_add_u32 s60, s60, 0x1fff00
    s_load_dword s59, s[40:41], s60
    s_cmp_lg_u32 s4, 0
    s_cbranch_scc1 tlbn_2
    s_load_dword s3, s[20:21], 0
tlbn_2:
    s_cmp_lg_u32 s4, 1
    s_cbranch_scc1 tlbn_3
    s_load_dword s3, s[24:25], 0
tlbn_3:
    s_cmp_lg_u32 s4, 2
    s_cbranch_scc1 tlbn_4
    s_load_dword s3, s[32:33], 0
tlbn_4:
    s_cmp_lg_u32 s4, 3
    s_cbranch_scc1 tlbn_5
    s_load_dword s3, s[36:37], 0
tlbn_5:
    s_cmp_lg_u32 s4, 4
    s_cbranch_scc1 tlbn_6
    s_load_dword s3, s[28:29], 0
tlbn_6:
    v_mov_b32 v4, 0
    v_lshl_add_u32 v5, v1, 2, v2
    ds_write_b32 v5, v4
    v_and_b32 v4, 31, v1
    v_lshrrev_b32 v5, 5, v1
    v_bfe_u32 v6, v1, 1, 3
    v_xor_b32 v5, v5, v6
    v_lshlrev_b32 v5, 4, v5
    v_lshl_add_u32 v4, v4, 7, v5
    s_lshl_b32 s63, s47, 5
    v_xor_b32 v4, s63, v4
    s_lshl_b32 s63, s47, 12
    s_add_u32 s63, s63, 28672
    v_xor_b32 v12, 0, v4
    v_add_u32 v12, s63, v12
    v_xor_b32 v13, 32, v4
    v_add_u32 v13, s63, v13
    v_xor_b32 v14, 64, v4
    v_add_u32 v14, s63, v14
    v_xor_b32 v15, 96, v4
    v_add_u32 v15, s63, v15
    v_lshrrev_b32 v4, 5, v1
    v_bfe_u32 v5, v1, 2, 2
    v_lshl_add_u32 v4, v4, 3, v5
    v_lshlrev_b32 v4, 6, v4
    v_bfe_u32 v5, v1, 4, 1
    v_lshl_add_u32 v4, v5, 5, v4
    v_and_b32 v5, 3, v1
    v_lshl_add_u32 v4, v5, 3, v4
    v_add_u32 v4, s65, v4
    s_xor_b32 s63, s47, 0
    s_lshl_b32 s63, s63, 10
    v_add_u32 v248, s63, v4
    s_xor_b32 s63, s47, 1
    s_lshl_b32 s63, s63, 10
    v_add_u32 v249, s63, v4
    s_xor_b32 s63, s47, 2
    s_lshl_b32 s63, s63, 10
    v_add_u32 v250, s63, v4
    s_xor_b32 s63, s47, 3
    s_lshl_b32 s63, s63, 10
    v_add_u32 v251, s63, v4
    v_lshlrev_b32 v7, 4, v1
    v_add_u32 v253, 162816, v7
    s_lshl_b32 s63, s47, 2
    v_add_u32 v252, s63, v253
    s_add_u32 s60, s77, 157696
    v_add_u32 v247, s60, v7
    v_cmp_gt_u32 vcc, 32, v1
    s_nop 1
    v_cndmask_b32 v11, 0, -1, vcc
    v_and_b32 v4, 31, v1
    v_mov_b32 v244, v4
    v_cmp_lt_u32 vcc, 11, v4
    s_nop 1
    v_cndmask_b32 v5, 0, v3, vcc
    v_sub_u32 v244, v244, v5
    v_cmp_lt_u32 vcc, 15, v4
    s_nop 1
    v_cndmask_b32 v5, 0, v3, vcc
    v_sub_u32 v244, v244, v5
    v_cmp_lt_u32 vcc, 27, v4
    s_nop 1
    v_cndmask_b32 v5, 0, v3, vcc
    v_sub_u32 v244, v244, v5
    v_min_u32 v244, 27, v244
    v_lshlrev_b32 v244, 1, v244
    v_lshrrev_b32 v5, 5, v1
    v_mul_u32_u24 v5, 224, v5
    s_lshr_b32 s60, s4, 1
    s_lshl_b32 s60, s60, 3
    s_and_b32 s61, s4, 1
    s_lshl_b32 s61, s61, 1
    s_add_u32 s60, s60, s61
    s_mul_i32 s60, s60, 56
    s_add_u32 s60, s60, 143360
    v_add3_u32 v244, v244, v5, s60
    v_and_b32 v4, 11, v4
    v_cmp_ne_u32 vcc, 11, v4
    s_nop 1
    v_cndmask_b32 v245, 0, -1, vcc
    s_lshr_b32 s60, s4, 2
    s_lshl_b32 s60, s60, 10
    s_add_u32 s60, s60, s63
    s_add_u32 s60, s60, 147456
    v_add_u32 v246, s60, v7
    s_and_b32 s60, s2, 7
    s_lshl_b32 s44, s60, 1
    s_lshr_b32 s61, s2, 7
    s_add_u32 s44, s44, s61
    s_bfe_u32 s60, s2, 0x30003
    s_and_b32 s61, s2, 1
    s_add_u32 s60, s60, s61
    s_and_b32 s60, s60, 7
    s_lshr_b32 s7, 0x54, s60
    s_and_b32 s7, s7, 1
    s_lshl_b32 s60, s60, 2
    s_bitcmp1_b32 s2, 6
    s_mov_b32 s61, 0x65432e10
    s_cselect_b32 s45, 0xdcba9f87, s61
    s_lshr_b32 s45, s45, s60
    s_and_b32 s45, s45, 15
    s_cmp_ge_u32 s45, 7
    s_cselect_b32 s53, 1, 0
    s_mul_i32 s63, s53, 7
    s_sub_u32 s54, s45, s63
    s_and_b32 s55, s47, 1
    s_lshr_b32 s56, s47, 1
    s_lshr_b32 s61, s2, 7
    s_mul_i32 s63, s61, 0
    s_add_u32 s52, s45, s63
    s_and_b32 s63, s2, 6
    s_add_u32 s52, s52, s63
    s_cmp_ge_u32 s52, 14
    s_cselect_b32 s63, 14, 0
    s_sub_u32 s52, s52, s63
    s_cmp_ge_u32 s52, 14
    s_cselect_b32 s63, 14, 0
    s_sub_u32 s52, s52, s63
    s_xor_b32 s100, s54, s53
    s_and_b32 s100, s100, 1
    s_mul_i32 s100, s100, 3
    s_bfe_u32 s60, s2, 0x30003
    s_and_b32 s61, s2, 1
    s_add_u32 s60, s60, s61
    s_and_b32 s60, s60, 7
    s_add_u32 s60, s60, 1
    s_lshr_b32 s60, s60, 1
    s_lshr_b32 s61, s2, 6
    s_mul_i32 s61, s61, 5
    s_add_u32 s60, s60, s61
    s_and_b32 s61, s2, 7
    s_mul_i32 s63, s60, 6784
    s_add_u32 s63, s63, 1221120
    s_mov_b32 s6, s63
    s_mul_i32 s63, s60, 6784
    s_add_u32 s63, s63, 1221120
    s_cmp_eq_u32 s4, 1
    s_cselect_b32 s6, s63, s6
    s_mul_i32 s63, s60, 6784
    s_add_u32 s63, s63, 1221120
    s_cmp_eq_u32 s4, 2
    s_cselect_b32 s6, s63, s6
    s_mul_i32 s63, s60, 6656
    s_lshl_b32 s64, s61, 18
    s_add_u32 s63, s63, s64
    s_add_u32 s63, s63, 2097152
    s_cmp_eq_u32 s4, 3
    s_cselect_b32 s6, s63, s6
    s_mul_i32 s63, s60, 6656
    s_lshl_b32 s64, s61, 18
    s_add_u32 s63, s63, s64
    s_add_u32 s63, s63, 2230272
    s_cmp_eq_u32 s4, 4
    s_cselect_b32 s6, s63, s6
    s_mul_i32 s63, s60, 8192
    s_add_u32 s63, s63, 16220160
    s_cmp_eq_u32 s4, 5
    s_cselect_b32 s6, s63, s6
    s_mul_i32 s63, s61, 20
    s_add_u32 s63, s63, s60
    s_lshl_b32 s63, s63, 13
    s_cmp_eq_u32 s4, 6
    s_cselect_b32 s6, s63, s6
    s_mul_i32 s63, s61, 20
    s_add_u32 s63, s63, s60
    s_lshl_b32 s63, s63, 13
    s_cmp_eq_u32 s4, 7
    s_cselect_b32 s6, s63, s6
    s_cmp_ge_u32 s4, 4
    s_cbranch_scc1 pre_7
    s_lshl_b32 s60, s4, 13
    s_lshl_b32 s61, s44, 9
    s_add_u32 s60, s60, s61
    s_add_u32 s62, s40, s60
    s_addc_u32 s63, s41, 0
    s_load_dword s57, s[62:63], 4096
    s_load_dword s57, s[62:63], 4160
    s_load_dword s57, s[62:63], 4224
    s_load_dword s57, s[62:63], 4288
    s_load_dword s57, s[62:63], 4352
    s_load_dword s57, s[62:63], 4416
    s_load_dword s57, s[62:63], 4480
    s_load_dword s57, s[62:63], 4544
pre_7:
    s_mul_i32 s60, s46, 1568
    s_add_u32 s16, s16, s60
    s_addc_u32 s17, s17, 0
    s_lshl_b32 s60, s67, 7
    s_add_u32 s60, s60, s51
    s_add_u32 m0, s76, 16384
    s_nop 0
    buffer_load_dwordx4 v8, s[8:11], s60 offen lds
    s_add_u32 m0, s76, 17408
    s_nop 0
    buffer_load_dwordx4 v9, s[8:11], s60 offen lds
    v_mov_b32 v254, 12
    buffer_load_dword v254, v254, s[40:43], 0 offen
    s_cmp_ge_u32 s4, 4
    s_cbranch_scc1 L_roleB
    s_setprio 1
    s_mul_i32 s60, s68, 172032
    s_add_u32 s60, s60, s78
    s_add_u32 s60, s60, 896
    s_add_u32 m0, s77, 8192
    s_nop 0
    buffer_load_dwordx4 v10, s[12:15], s60 offen lds
    v_lshlrev_b32 v140, 4, v1
    s_add_u32 m0, s77, 143360
    s_nop 0
    buffer_load_dwordx4 v140, s[16:19], s77 offen lds
    v_mov_b32 v93, 0
    v_mov_b32 v98, 0
    v_mov_b32 v99, 0
    s_waitcnt vmcnt(5)
    s_waitcnt lgkmcnt(0)
    s_barrier
    ds_read_b128 v[16:19], v12 offset:0
    ds_read_b64_tr_b16 v[32:33], v248 offset:0
    ds_read_b64_tr_b16 v[34:35], v248 offset:256
    ds_read_b128 v[20:23], v13 offset:0
    ds_read_b64_tr_b16 v[36:37], v249 offset:0
    ds_read_b64_tr_b16 v[38:39], v249 offset:256
    ds_read_b128 v[24:27], v14 offset:0
    ds_read_b64_tr_b16 v[40:41], v250 offset:0
    ds_read_b64_tr_b16 v[42:43], v250 offset:256
    ds_read_b128 v[28:31], v15 offset:0
    ds_read_b64_tr_b16 v[44:45], v251 offset:0
    ds_read_b64_tr_b16 v[46:47], v251 offset:256
    s_mul_i32 s60, s69, 172032
    s_add_u32 s60, s60, s78
    s_add_u32 s60, s60, 896
    s_add_u32 m0, s77, 12288
    s_nop 0
    buffer_load_dwordx4 v10, s[12:15], s60 offen lds
    s_lshl_b32 s60, s68, 7
    s_add_u32 s60, s60, s51
    s_add_u32 m0, s76, 32768
    s_nop 0
    buffer_load_dwordx4 v8, s[8:11], s60 offen lds
    s_add_u32 m0, s76, 33792
    s_nop 0
    buffer_load_dwordx4 v9, s[8:11], s60 offen lds
    s_waitcnt lgkmcnt(9)
    v_dot2c_f32_bf16 v93, s73, v32
    v_dot2c_f32_bf16 v93, s73, v33
    v_dot2c_f32_bf16 v93, s73, v34
    v_dot2c_f32_bf16 v93, s73, v35
    v_mfma_f32_32x32x16_bf16 v[64:79], v[32:35], v[16:19], 0
    ds_read_b64_tr_b16 v[48:49], v248 offset:4096
    ds_read_b64_tr_b16 v[50:51], v248 offset:4352
    s_waitcnt lgkmcnt(8)
    v_mfma_f32_32x32x16_bf16 v[64:79], v[36:39], v[20:23], v[64:79]
    ds_read_b64_tr_b16 v[52:53], v249 offset:4096
    ds_read_b64_tr_b16 v[54:55], v249 offset:4352
    s_waitcnt lgkmcnt(7)
    v_mfma_f32_32x32x16_bf16 v[64:79], v[40:43], v[24:27], v[64:79]
    ds_read_b64_tr_b16 v[56:57], v250 offset:4096
    ds_read_b64_tr_b16 v[58:59], v250 offset:4352
    s_waitcnt lgkmcnt(6)
    v_mfma_f32_32x32x16_bf16 v[64:79], v[44:47], v[28:31], v[64:79]
    ds_read_b64_tr_b16 v[60:61], v251 offset:4096
    ds_read_b64_tr_b16 v[62:63], v251 offset:4352
    s_waitcnt vmcnt(4)
    s_waitcnt lgkmcnt(0)
    s_barrier
    ds_read_b128 v[16:19], v12 offset:16384
    ds_read_b128 v[20:23], v13 offset:16384
    ds_read_b128 v[24:27], v14 offset:16384
    ds_read_b128 v[28:31], v15 offset:16384
    s_mul_i32 s60, s70, 172032
    s_add_u32 s60, s60, s78
    s_add_u32 s60, s60, 896
    s_add_u32 m0, s77, 16384
    s_nop 0
    buffer_load_dwordx4 v10, s[12:15], s60 offen lds
    s_lshl_b32 s60, s69, 7
    s_add_u32 s60, s60, s51
    s_add_u32 m0, s76, 49152
    s_nop 0
    buffer_load_dwordx4 v8, s[8:11], s60 offen lds
    s_add_u32 m0, s76, 50176
    s_nop 0
    buffer_load_dwordx4 v9, s[8:11], s60 offen lds
    v_dot2c_f32_bf16 v93, s73, v48
    v_dot2c_f32_bf16 v93, s73, v49
    v_dot2c_f32_bf16 v93, s73, v50
    v_dot2c_f32_bf16 v93, s73, v51
    s_waitcnt lgkmcnt(3)
    v_mfma_f32_32x32x16_bf16 v[64:79], v[48:51], v[16:19], v[64:79]
    ds_read_b64_tr_b16 v[32:33], v248 offset:8192
    ds_read_b64_tr_b16 v[34:35], v248 offset:8448
    s_waitcnt lgkmcnt(4)
    v_mfma_f32_32x32x16_bf16 v[64:79], v[52:55], v[20:23], v[64:79]
    ds_read_b64_tr_b16 v[36:37], v249 offset:8192
    ds_read_b64_tr_b16 v[38:39], v249 offset:8448
    s_waitcnt lgkmcnt(5)
    v_mfma_f32_32x32x16_bf16 v[64:79], v[56:59], v[24:27], v[64:79]
    ds_read_b64_tr_b16 v[40:41], v250 offset:8192
    ds_read_b64_tr_b16 v[42:43], v250 offset:8448
    s_waitcnt lgkmcnt(6)
    v_mfma_f32_32x32x16_bf16 v[64:79], v[60:63], v[28:31], v[64:79]
    ds_read_b64_tr_b16 v[44:45], v251 offset:8192
    ds_read_b64_tr_b16 v[46:47], v251 offset:8448
    s_waitcnt vmcnt(3)
    s_waitcnt lgkmcnt(0)
    s_barrier
    ds_read_b128 v[16:19], v12 offset:32768
    ds_read_b128 v[20:23], v13 offset:32768
    ds_read_b128 v[24:27], v14 offset:32768
    ds_read_b128 v[28:31], v15 offset:32768
    ds_read_u16 v140, v244
    ds_read_u16 v141, v244 offset:56
    s_mul_i32 s60, s71, 172032
    s_add_u32 s60, s60, s78
    s_add_u32 s60, s60, 896
    s_add_u32 m0, s77, 20480
    s_nop 0
    buffer_load_dwordx4 v10, s[12:15], s60 offen lds
    s_lshl_b32 s60, s70, 7
    s_add_u32 s60, s60, s51
    s_add_u32 m0, s76, 65536
    s_nop 0
    buffer_load_dwordx4 v8, s[8:11], s60 offen lds
    s_add_u32 m0, s76, 66560
    s_nop 0
    buffer_load_dwordx4 v9, s[8:11], s60 offen lds
    v_dot2c_f32_bf16 v93, s73, v32
    v_dot2c_f32_bf16 v93, s73, v33
    v_dot2c_f32_bf16 v93, s73, v34
    v_dot2c_f32_bf16 v93, s73, v35
    s_waitcnt lgkmcnt(5)
    v_mfma_f32_32x32x16_bf16 v[64:79], v[32:35], v[16:19], v[64:79]
    ds_read_b64_tr_b16 v[48:49], v248 offset:12288
    ds_read_b64_tr_b16 v[50:51], v248 offset:12544
    s_waitcnt lgkmcnt(6)
    v_mfma_f32_32x32x16_bf16 v[64:79], v[36:39], v[20:23], v[64:79]
    ds_read_b64_tr_b16 v[52:53], v249 offset:12288
    ds_read_b64_tr_b16 v[54:55], v249 offset:12544
    s_waitcnt lgkmcnt(7)
    v_mfma_f32_32x32x16_bf16 v[64:79], v[40:43], v[24:27], v[64:79]
    ds_read_b64_tr_b16 v[56:57], v250 offset:12288
    ds_read_b64_tr_b16 v[58:59], v250 offset:12544
    s_waitcnt lgkmcnt(8)
    v_mfma_f32_32x32x16_bf16 v[64:79], v[44:47], v[28:31], v[64:79]
    ds_read_b64_tr_b16 v[60:61], v251 offset:12288
    ds_read_b64_tr_b16 v[62:63], v251 offset:12544
    s_waitcnt lgkmcnt(8)
    v_lshl_or_b32 v140, v141, 16, v140
    v_and_b32 v140, v140, v245
    ds_write_b32 v246, v140
    s_waitcnt vmcnt(3)
    s_waitcnt lgkmcnt(0)
    s_barrier
    ds_read_b128 v[16:19], v12 offset:49152
    ds_read_b128 v[20:23], v13 offset:49152
    ds_read_b128 v[24:27], v14 offset:49152
    ds_read_b128 v[28:31], v15 offset:49152
    s_mul_i32 s60, s72, 172032
    s_add_u32 s60, s60, s78
    s_add_u32 s60, s60, 896
    s_add_u32 m0, s77, 24576
    s_nop 0
    buffer_load_dwordx4 v10, s[12:15], s60 offen lds
    s_lshl_b32 s60, s71, 7
    s_add_u32 s60, s60, s51
    s_add_u32 m0, s76, 81920
    s_nop 0
    buffer_load_dwordx4 v8, s[8:11], s60 offen lds
    s_add_u32 m0, s76, 82944
    s_nop 0
    buffer_load_dwordx4 v9, s[8:11], s60 offen lds
    v_dot2c_f32_bf16 v93, s73, v48
    v_dot2c_f32_bf16 v93, s73, v49
    v_dot2c_f32_bf16 v93, s73, v50
    v_dot2c_f32_bf16 v93, s73, v51
    s_waitcnt lgkmcnt(3)
    v_mfma_f32_32x32x16_bf16 v[64:79], v[48:51], v[16:19], v[64:79]
    ds_read_b64_tr_b16 v[32:33], v248 offset:16384
    ds_read_b64_tr_b16 v[34:35], v248 offset:16640
    s_waitcnt lgkmcnt(4)
    v_mfma_f32_32x32x16_bf16 v[64:79], v[52:55], v[20:23], v[64:79]
    ds_read_b64_tr_b16 v[36:37], v249 offset:16384
    ds_read_b64_tr_b16 v[38:39], v249 offset:16640
    s_waitcnt lgkmcnt(5)
    v_mfma_f32_32x32x16_bf16 v[64:79], v[56:59], v[24:27], v[64:79]
    ds_read_b64_tr_b16 v[40:41], v250 offset:16384
    ds_read_b64_tr_b16 v[42:43], v250 offset:16640
    s_waitcnt lgkmcnt(6)
    v_mfma_f32_32x32x16_bf16 v[64:79], v[60:63], v[28:31], v[64:79]
    ds_read_b64_tr_b16 v[44:45], v251 offset:16384
    ds_read_b64_tr_b16 v[46:47], v251 offset:16640
    v_add_u32 v12, 0x10000, v12
    v_add_u32 v13, 0x10000, v13
    v_add_u32 v14, 0x10000, v14
    v_add_u32 v15, 0x10000, v15
    v_readfirstlane_b32 s48, v254
    s_nop 0
    s_lshr_b32 s63, s48, 16
    s_mul_i32 s48, s48, 1664525
    s_add_u32 s48, s48, 1013904223
    s_and_b32 s49, s48, 0x1fff
    s_or_b32 s49, s49, 0x2000
    s_bfe_u32 s64, s48, 0x1000d
    s_lshl_b32 s64, s64, 15
    s_or_b32 s49, s49, s64
    s_cmp_lg_u32 s49, s63
    s_cbranch_scc1 mt_9
    s_mul_i32 s48, s48, 1664525
    s_add_u32 s48, s48, 1013904223
    s_and_b32 s49, s48, 0x1fff
    s_or_b32 s49, s49, 0x2000
    s_bfe_u32 s64, s48, 0x1000d
    s_lshl_b32 s64, s64, 15
    s_or_b32 s49, s49, s64
mt_9:
    s_lshl_b32 s50, s49, 16
    s_waitcnt vmcnt(3)
    s_waitcnt lgkmcnt(0)
    s_barrier
    ds_read_b128 v[16:19], v12 offset:0
    ds_read_b128 v[20:23], v13 offset:0
    ds_read_b128 v[24:27], v14 offset:0
    ds_read_b128 v[28:31], v15 offset:0
    s_lshl_b32 s60, s72, 7
    s_add_u32 s60, s60, s51
    s_add_u32 m0, s76, 98304
    s_nop 0
    buffer_load_dwordx4 v8, s[8:11], s60 offen lds
    s_add_u32 m0, s76, 99328
    s_nop 0
    buffer_load_dwordx4 v9, s[8:11], s60 offen lds
    v_dot2c_f32_bf16 v93, s73, v32
    v_dot2c_f32_bf16 v93, s73, v33
    v_dot2c_f32_bf16 v93, s73, v34
    v_dot2c_f32_bf16 v93, s73, v35
    s_waitcnt lgkmcnt(3)
    v_mfma_f32_32x32x16_bf16 v[64:79], v[32:35], v[16:19], v[64:79]
    ds_read_b64_tr_b16 v[48:49], v248 offset:20480
    ds_read_b64_tr_b16 v[50:51], v248 offset:20736
    s_waitcnt lgkmcnt(4)
    v_mfma_f32_32x32x16_bf16 v[64:79], v[36:39], v[20:23], v[64:79]
    ds_read_b64_tr_b16 v[52:53], v249 offset:20480
    ds_read_b64_tr_b16 v[54:55], v249 offset:20736
    s_waitcnt lgkmcnt(5)
    v_mfma_f32_32x32x16_bf16 v[64:79], v[40:43], v[24:27], v[64:79]
    ds_read_b64_tr_b16 v[56:57], v250 offset:20480
    ds_read_b64_tr_b16 v[58:59], v250 offset:20736
    s_waitcnt lgkmcnt(6)
    v_mfma_f32_32x32x16_bf16 v[64:79], v[44:47], v[28:31], v[64:79]
    ds_read_b64_tr_b16 v[60:61], v251 offset:20480
    ds_read_b64_tr_b16 v[62:63], v251 offset:20736
    v_lshlrev_b32 v4, 4, v1
    v_add_u32 v4, 147456, v4
    ds_read_b128 v[80:83], v4
    ds_read_b128 v[84:87], v4 offset:1024
    s_waitcnt vmcnt(2)
    s_waitcnt lgkmcnt(0)
    s_barrier
    ds_read_b128 v[16:19], v12 offset:16384
    ds_read_b128 v[20:23], v13 offset:16384
    ds_read_b128 v[24:27], v14 offset:16384
    ds_read_b128 v[28:31], v15 offset:16384
    s_cmp_eq_u32 s7, 0
    s_cbranch_scc0 var_10
    s_mul_i32 s60, s66, 172032
    s_add_u32 s60, s60, s78
    s_add_u32 m0, s77, 61440
    s_nop 0
    buffer_load_dwordx4 v10, s[12:15], s60 offen lds
    s_mul_i32 s60, s67, 172032
    s_add_u32 s60, s60, s78
    s_add_u32 m0, s77, 65536
    s_nop 0
    buffer_load_dwordx4 v10, s[12:15], s60 offen lds
var_10:
    v_dot2c_f32_bf16 v93, s73, v48
    v_dot2c_f32_bf16 v93, s73, v49
    v_dot2c_f32_bf16 v93, s73, v50
    v_dot2c_f32_bf16 v93, s73, v51
    s_waitcnt lgkmcnt(3)
    v_mfma_f32_32x32x16_bf16 v[64:79], v[48:51], v[16:19], v[64:79]
    ds_read_b64_tr_b16 v[32:33], v248 offset:24576
    ds_read_b64_tr_b16 v[34:35], v248 offset:24832
    s_waitcnt lgkmcnt(4)
    v_mfma_f32_32x32x16_bf16 v[64:79], v[52:55], v[20:23], v[64:79]
    ds_read_b64_tr_b16 v[36:37], v249 offset:24576
    ds_read_b64_tr_b16 v[38:39], v249 offset:24832
    s_waitcnt lgkmcnt(5)
    v_mfma_f32_32x32x16_bf16 v[64:79], v[56:59], v[24:27], v[64:79]
    ds_read_b64_tr_b16 v[40:41], v250 offset:24576
    ds_read_b64_tr_b16 v[42:43], v250 offset:24832
    s_waitcnt lgkmcnt(6)
    v_mfma_f32_32x32x16_bf16 v[64:79], v[60:63], v[28:31], v[64:79]
    ds_read_b64_tr_b16 v[44:45], v251 offset:24576
    ds_read_b64_tr_b16 v[46:47], v251 offset:24832
    s_waitcnt lgkmcnt(6)
    v_dot2c_f32_bf16 v93, s73, v32
    v_dot2c_f32_bf16 v93, s73, v33
    v_dot2c_f32_bf16 v93, s73, v34
    v_dot2c_f32_bf16 v93, s73, v35
    s_nop 2
    ds_write_b32 v252, v93
    s_waitcnt vmcnt(2)
    s_cmp_eq_u32 s7, 0
    s_cbranch_scc1 var_11
    s_waitcnt vmcnt(0)
var_11:
    s_waitcnt lgkmcnt(0)
    s_barrier
    ds_read_b128 v[16:19], v12 offset:32768
    ds_read_b128 v[20:23], v13 offset:32768
    ds_read_b128 v[24:27], v14 offset:32768
    ds_read_b128 v[28:31], v15 offset:32768
    ds_read_b128 v[144:147], v253
    s_cmp_eq_u32 s7, 0
    s_cbranch_scc0 var_12
    s_mul_i32 s60, s68, 172032
    s_add_u32 s60, s60, s78
    s_add_u32 m0, s77, 69632
    s_nop 0
    buffer_load_dwordx4 v10, s[12:15], s60 offen lds
    s_mul_i32 s60, s69, 172032
    s_add_u32 s60, s60, s78
    s_add_u32 m0, s77, 73728
    s_nop 0
    buffer_load_dwordx4 v10, s[12:15], s60 offen lds
    s_mul_i32 s60, s70, 172032
    s_add_u32 s60, s60, s78
    s_add_u32 m0, s77, 77824
    s_nop 0
    buffer_load_dwordx4 v10, s[12:15], s60 offen lds
var_12:
    v_and_b32 v4, 31, v1
    v_lshrrev_b32 v5, 5, v1
    v_bfe_u32 v6, v1, 1, 3
    v_xor_b32 v5, v5, v6
    v_lshlrev_b32 v5, 3, v5
    v_lshl_add_u32 v4, v4, 6, v5
    s_lshl_b32 s60, s47, 11
    v_add_u32 v4, s60, v4
    v_xor_b32 v12, 0, v4
    v_xor_b32 v13, 16, v4
    v_xor_b32 v14, 32, v4
    v_xor_b32 v15, 48, v4
    s_waitcnt lgkmcnt(0)
    v_add_f32 v144, v144, v145
    v_add_f32 v146, v146, v147
    v_add_f32 v93, v144, v146
    v_cvt_pk_bf16_f32 v140, 0, v93
    v_sub_f32 v141, v93, v140
    v_cvt_pk_bf16_f32 v96, v140, v140
    v_cvt_pk_bf16_f32 v97, v141, 0
    v_mfma_f32_32x32x16_bf16 v[64:79], v[32:35], v[16:19], v[64:79]
    v_mfma_f32_32x32x16_bf16 v[64:79], v[36:39], v[20:23], v[64:79]
    v_mfma_f32_32x32x16_bf16 v[64:79], v[40:43], v[24:27], v[64:79]
    v_mfma_f32_32x32x16_bf16 v[64:79], v[44:47], v[28:31], v[64:79]
    s_barrier
    ds_read_b128 v[88:91], v247
    s_cmp_eq_u32 s7, 0
    s_cbranch_scc0 var_13
    s_mul_i32 s60, s71, 172032
    s_add_u32 s60, s60, s78
    s_add_u32 m0, s77, 81920
    s_nop 0
    buffer_load_dwordx4 v10, s[12:15], s60 offen lds
    s_mul_i32 s60, s72, 172032
    s_add_u32 s60, s60, s78
    s_add_u32 m0, s77, 86016
    s_nop 0
    buffer_load_dwordx4 v10, s[12:15], s60 offen lds
var_13:
    s_waitcnt lgkmcnt(0)
    v_mul_f32 v92, 0x3fb8aa3b, v90
    v_mov_b32 v90, 0
    s_nop 1
    v_mfma_f32_32x32x16_bf16 v[64:79], v[96:99], v[88:91], v[64:79]
    s_nop 11
    v_cvt_pk_bf16_f32 v100, v64, v65
    v_cvt_pk_bf16_f32 v101, v66, v67
    v_cvt_pk_bf16_f32 v102, v68, v69
    v_cvt_pk_bf16_f32 v103, v70, v71
    v_cvt_pk_bf16_f32 v104, v72, v73
    v_cvt_pk_bf16_f32 v105, v74, v75
    v_cvt_pk_bf16_f32 v106, v76, v77
    v_cvt_pk_bf16_f32 v107, v78, v79
    v_and_b32 v106, v106, v11
    v_and_b32 v107, v107, v11
    v_mfma_f32_32x32x16_bf16 v[108:123], v[80:83], v[100:103], 0
    s_nop 0
    v_mfma_f32_32x32x16_bf16 v[108:123], v[84:87], v[104:107], v[108:123]
    v_lshrrev_b32 v4, 5, v1
    v_bfe_u32 v5, v1, 2, 2
    v_lshl_add_u32 v6, v4, 3, v5
    v_lshrrev_b32 v5, 1, v5
    v_lshl_add_u32 v4, v4, 2, v5
    v_bfe_u32 v5, v1, 4, 1
    v_lshlrev_b32 v5, 2, v5
    v_and_b32 v7, 3, v1
    v_or_b32 v5, v5, v7
    v_xor_b32 v4, v4, v5
    v_lshlrev_b32 v4, 3, v4
    v_lshl_add_u32 v16, v6, 6, v4
    v_xor_b32 v17, 16, v16
    v_add_u32 v17, 256, v17
    s_lshl_b32 s60, s47, 13
    v_add_u32 v18, s60, v16
    v_add_u32 v19, s60, v17
    v_lshlrev_b32 v20, 4, v1
    v_mov_b32 v21, s50
    s_lshl_b32 s62, s46, 16
    s_lshl_b32 s63, s5, 12
    s_add_u32 s62, s62, s63
    s_lshl_b32 s63, s47, 11
    s_add_u32 s62, s62, s63
    s_add_u32 s62, s62, 1048576
    v_max3_f32 v140, v108, v109, v110
    v_min3_f32 v142, v108, v109, v110
    v_max3_f32 v140, v140, v111, v112
    v_min3_f32 v142, v142, v111, v112
    v_max3_f32 v140, v140, v113, v114
    v_min3_f32 v142, v142, v113, v114
    v_max3_f32 v140, v140, v116, v117
    v_min3_f32 v142, v142, v116, v117
    v_max3_f32 v140, v140, v118, v119
    v_min3_f32 v142, v142, v118, v119
    v_max3_f32 v140, v140, v120, v121
    v_min3_f32 v142, v142, v120, v121
    v_max_f32 v140, v140, v122
    v_min_f32 v142, v142, v122
    v_mov_b32 v141, v140
    v_mov_b32 v143, v142
    s_nop 0
    v_permlane32_swap_b32 v140, v141
    v_permlane32_swap_b32 v142, v143
    v_max_f32 v140, v140, v141
    v_min_f32 v142, v142, v143
    v_mul_f32 v140, v140, v92
    v_mul_f32 v142, v142, v92
    s_cmp_eq_u32 s7, 0
    s_cbranch_scc0 var_14
    v_lshlrev_b32 v4, 7, v1
    s_cmp_gt_u32 s47, 2
    s_cbranch_scc1 tch_16
    buffer_load_dword v255, v4, s[20:23], s6 offen
    s_branch tch_15
tch_16:
    buffer_load_dword v255, v4, s[40:43], s6 offen sc1
tch_17:
tch_15:
var_14:
    s_cmp_eq_u32 s7, 0
    s_cbranch_scc1 var_18
    s_mul_i32 s60, s66, 172032
    s_add_u32 s60, s60, s78
    s_add_u32 m0, s77, 61440
    s_nop 0
    buffer_load_dwordx4 v10, s[12:15], s60 offen lds
    s_mul_i32 s60, s67, 172032
    s_add_u32 s60, s60, s78
    s_add_u32 m0, s77, 65536
    s_nop 0
    buffer_load_dwordx4 v10, s[12:15], s60 offen lds
var_18:
    v_fma_f32 v124, -v108, v92, v142
    v_fma_f32 v108, v108, v92, -v140
    v_exp_f32 v124, v124
    v_exp_f32 v108, v108
    v_fma_f32 v125, -v109, v92, v142
    v_fma_f32 v109, v109, v92, -v140
    v_exp_f32 v125, v125
    v_exp_f32 v109, v109
    v_fma_f32 v126, -v110, v92, v142
    v_fma_f32 v110, v110, v92, -v140
    v_exp_f32 v126, v126
    v_exp_f32 v110, v110
    v_fma_f32 v127, -v111, v92, v142
    v_fma_f32 v111, v111, v92, -v140
    v_exp_f32 v127, v127
    v_exp_f32 v111, v111
    v_fma_f32 v128, -v112, v92, v142
    v_fma_f32 v112, v112, v92, -v140
    v_exp_f32 v128, v128
    v_exp_f32 v112, v112
    v_fma_f32 v129, -v113, v92, v142
    v_fma_f32 v113, v113, v92, -v140
    v_exp_f32 v129, v129
    v_exp_f32 v113, v113
    v_fma_f32 v130, -v114, v92, v142
    v_fma_f32 v114, v114, v92, -v140
    v_exp_f32 v130, v130
    v_exp_f32 v114, v114
    v_fma_f32 v132, -v116, v92, v142
    v_fma_f32 v116, v116, v92, -v140
    v_exp_f32 v132, v132
    v_exp_f32 v116, v116
    v_fma_f32 v133, -v117, v92, v142
    v_fma_f32 v117, v117, v92, -v140
    v_exp_f32 v133, v133
    v_exp_f32 v117, v117
    v_fma_f32 v134, -v118, v92, v142
    v_fma_f32 v118, v118, v92, -v140
    v_exp_f32 v134, v134
    v_exp_f32 v118, v118
    s_cmp_eq_u32 s7, 0
    s_cbranch_scc1 var_19
    s_mul_i32 s60, s68, 172032
    s_add_u32 s60, s60, s78
    s_add_u32 m0, s77, 69632
    s_nop 0
    buffer_load_dwordx4 v10, s[12:15], s60 offen lds
    s_mul_i32 s60, s69, 172032
    s_add_u32 s60, s60, s78
    s_add_u32 m0, s77, 73728
    s_nop 0
    buffer_load_dwordx4 v10, s[12:15], s60 offen lds
var_19:
    v_fma_f32 v135, -v119, v92, v142
    v_fma_f32 v119, v119, v92, -v140
    v_exp_f32 v135, v135
    v_exp_f32 v119, v119
    v_fma_f32 v136, -v120, v92, v142
    v_fma_f32 v120, v120, v92, -v140
    v_exp_f32 v136, v136
    v_exp_f32 v120, v120
    v_fma_f32 v137, -v121, v92, v142
    v_fma_f32 v121, v121, v92, -v140
    v_exp_f32 v137, v137
    v_exp_f32 v121, v121
    v_fma_f32 v138, -v122, v92, v142
    v_fma_f32 v122, v122, v92, -v140
    v_exp_f32 v138, v138
    v_exp_f32 v122, v122
    v_add_f32 v144, v108, v109
    v_add_f32 v146, v124, v125
    v_add_f32 v145, v110, v111
    v_add_f32 v147, v126, v127
    v_add_f32 v144, v144, v112
    v_add_f32 v146, v146, v128
    v_add_f32 v145, v145, v113
    v_add_f32 v147, v147, v129
    v_add_f32 v144, v144, v114
    v_add_f32 v146, v146, v130
    v_add_f32 v145, v145, v116
    v_add_f32 v147, v147, v132
    v_add_f32 v144, v144, v117
    v_add_f32 v146, v146, v133
    v_add_f32 v145, v145, v118
    v_add_f32 v147, v147, v134
    v_add_f32 v144, v144, v119
    v_add_f32 v146, v146, v135
    v_add_f32 v145, v145, v120
    v_add_f32 v147, v147, v136
    v_add_f32 v144, v144, v121
    v_add_f32 v146, v146, v137
    v_add_f32 v145, v145, v122
    v_add_f32 v147, v147, v138
    v_add_f32 v144, v144, v145
    v_add_f32 v146, v146, v147
    v_mov_b32 v141, v144
    v_mov_b32 v143, v146
    s_nop 0
    v_permlane32_swap_b32 v144, v141
    v_permlane32_swap_b32 v146, v143
    v_add_f32 v144, v144, v141
    v_add_f32 v146, v146, v143
    v_rcp_f32 v144, v144
    v_rcp_f32 v146, v146
    v_mul_f32 v108, v108, v144
    v_mul_f32 v124, v124, v146
    v_mul_f32 v109, v109, v144
    v_mul_f32 v125, v125, v146
    v_mul_f32 v110, v110, v144
    v_mul_f32 v126, v126, v146
    v_mul_f32 v111, v111, v144
    v_mul_f32 v127, v127, v146
    v_mul_f32 v112, v112, v144
    v_mul_f32 v128, v128, v146
    v_mul_f32 v113, v113, v144
    v_mul_f32 v129, v129, v146
    v_mul_f32 v114, v114, v144
    v_mul_f32 v130, v130, v146
    v_mul_f32 v116, v116, v144
    v_mul_f32 v132, v132, v146
    v_mul_f32 v117, v117, v144
    v_mul_f32 v133, v133, v146
    v_mul_f32 v118, v118, v144
    v_mul_f32 v134, v134, v146
    v_mul_f32 v119, v119, v144
    v_mul_f32 v135, v135, v146
    v_mul_f32 v120, v120, v144
    v_mul_f32 v136, v136, v146
    v_mul_f32 v121, v121, v144
    v_mul_f32 v137, v137, v146
    v_mul_f32 v122, v122, v144
    v_mul_f32 v138, v138, v146
    v_cvt_pk_bf16_f32 v148, v108, v109
    v_cvt_pk_bf16_f32 v156, v124, v125
    v_cvt_pk_bf16_f32 v149, v110, v111
    v_cvt_pk_bf16_f32 v157, v126, v127
    v_cvt_pk_bf16_f32 v150, v112, v113
    v_cvt_pk_bf16_f32 v158, v128, v129
    v_cvt_pk_bf16_f32 v151, v114, 0
    v_cvt_pk_bf16_f32 v159, v130, 0
    v_cvt_pk_bf16_f32 v152, v116, v117
    v_cvt_pk_bf16_f32 v160, v132, v133
    v_cvt_pk_bf16_f32 v153, v118, v119
    v_cvt_pk_bf16_f32 v161, v134, v135
    v_cvt_pk_bf16_f32 v154, v120, v121
    v_cvt_pk_bf16_f32 v162, v136, v137
    v_cvt_pk_bf16_f32 v155, v122, 0
    v_cvt_pk_bf16_f32 v163, v138, 0
    ds_write_b64 v12, v[148:149] offset:0
    ds_write_b64 v13, v[150:151] offset:0
    ds_write_b64 v14, v[152:153] offset:0
    ds_write_b64 v15, v[154:155] offset:0
    ds_write_b64 v12, v[156:157] offset:8192
    ds_write_b64 v13, v[158:159] offset:8192
    ds_write_b64 v14, v[160:161] offset:8192
    ds_write_b64 v15, v[162:163] offset:8192
    s_cmp_eq_u32 s7, 0
    s_cbranch_scc1 var_20
    s_mul_i32 s60, s70, 172032
    s_add_u32 s60, s60, s78
    s_add_u32 m0, s77, 77824
    s_nop 0
    buffer_load_dwordx4 v10, s[12:15], s60 offen lds
    s_mul_i32 s60, s71, 172032
    s_add_u32 s60, s60, s78
    s_add_u32 m0, s77, 81920
    s_nop 0
    buffer_load_dwordx4 v10, s[12:15], s60 offen lds
    s_mul_i32 s60, s72, 172032
    s_add_u32 s60, s60, s78
    s_add_u32 m0, s77, 86016
    s_nop 0
    buffer_load_dwordx4 v10, s[12:15], s60 offen lds
var_20:
    s_lshl_b32 s51, s44, 2
    s_lshl_b32 s60, s53, 1
    s_add_u32 s51, s51, s60
    s_add_u32 s51, s51, s55
    s_lshl_b32 s63, s54, 7
    s_mul_i32 s79, s51, 28672
    s_add_u32 s79, s79, s63
    s_lshl_b32 s60, s56, 6
    s_add_u32 s79, s79, s60
    v_and_b32 v4, 31, v1
    v_mul_u32_u24 v4, 896, v4
    v_lshrrev_b32 v5, 5, v1
    v_lshl_add_u32 v12, v5, 4, v4
    v_lshlrev_b32 v10, 4, v1
    v_mov_b32 v11, s50
    s_lshl_b32 s76, s46, 16
    s_add_u32 s76, s76, s77
    s_add_u32 s76, s76, 1048576
    s_add_u32 s60, s77, 157696
    v_add_u32 v9, s60, v10
    s_lshl_b32 s64, s5, 15
    v_mov_b32 v144, 0
    v_mov_b32 v145, 0
    v_mov_b32 v146, 0
    v_mov_b32 v147, 0
    v_mov_b32 v148, 0
    v_mov_b32 v149, 0
    v_mov_b32 v150, 0
    s_cmp_ge_u32 s47, 2
    s_cbranch_scc1 akv_21
    buffer_load_dwordx4 v[240:243], v12, s[8:11], s79 offen offset:0
    buffer_load_dwordx4 v[244:247], v12, s[8:11], s79 offen offset:32
    s_lshl_b32 s72, s51, 15
    s_lshl_b32 s60, s56, 13
    s_add_u32 s72, s72, s60
    s_add_u32 s72, s72, 2097152
    v_lshrrev_b32 v4, 5, v1
    v_bfe_u32 v7, v1, 2, 2
    v_lshl_add_u32 v14, v4, 3, v7
    v_bfe_u32 v5, v1, 4, 1
    v_lshlrev_b32 v5, 1, v5
    v_bfe_u32 v6, v1, 1, 1
    v_or_b32 v5, v5, v6
    v_bfe_u32 v6, v14, 1, 1
    v_lshlrev_b32 v6, 2, v6
    v_xor_b32 v5, v5, v6
    v_lshlrev_b32 v5, 4, v5
    v_and_b32 v6, 1, v1
    v_lshl_add_u32 v5, v6, 3, v5
    v_lshl_add_u32 v248, v14, 7, v5
    v_xor_b32 v249, 64, v248
    v_lshrrev_b32 v4, 5, v1
    v_mul_u32_u24 v4, 3, v4
    v_bfe_u32 v7, v1, 2, 2
    v_min_u32 v7, 2, v7
    v_add3_u32 v4, v4, v7, 0
    v_lshrrev_b32 v7, 2, v4
    v_and_b32 v4, 3, v4
    v_lshl_add_u32 v14, v7, 3, v4
    v_add_u32 v14, 4, v14
    v_bfe_u32 v5, v1, 4, 1
    v_lshlrev_b32 v5, 1, v5
    v_bfe_u32 v6, v1, 1, 1
    v_or_b32 v5, v5, v6
    v_bfe_u32 v6, v14, 1, 1
    v_lshlrev_b32 v6, 2, v6
    v_xor_b32 v5, v5, v6
    v_lshlrev_b32 v5, 4, v5
    v_and_b32 v6, 1, v1
    v_lshl_add_u32 v5, v6, 3, v5
    v_lshl_add_u32 v250, v14, 7, v5
    v_xor_b32 v251, 64, v250
    v_lshrrev_b32 v4, 5, v1
    v_mul_u32_u24 v4, 3, v4
    v_bfe_u32 v7, v1, 2, 2
    v_min_u32 v7, 2, v7
    v_add3_u32 v4, v4, v7, 6
    v_lshrrev_b32 v7, 2, v4
    v_and_b32 v4, 3, v4
    v_lshl_add_u32 v14, v7, 3, v4
    v_add_u32 v14, 4, v14
    v_bfe_u32 v5, v1, 4, 1
    v_lshlrev_b32 v5, 1, v5
    v_bfe_u32 v6, v1, 1, 1
    v_or_b32 v5, v5, v6
    v_bfe_u32 v6, v14, 1, 1
    v_lshlrev_b32 v6, 2, v6
    v_xor_b32 v5, v5, v6
    v_lshlrev_b32 v5, 4, v5
    v_and_b32 v6, 1, v1
    v_lshl_add_u32 v5, v6, 3, v5
    v_lshl_add_u32 v252, v14, 7, v5
    v_xor_b32 v253, 64, v252
    s_lshl_b32 s60, s56, 6
    s_mul_i32 s61, s56, 28672
    s_add_u32 s61, s61, 100352
    v_xor_b32 v248, s60, v248
    v_add_u32 v248, s61, v248
    v_xor_b32 v249, s60, v249
    v_add_u32 v249, s61, v249
    v_xor_b32 v250, s60, v250
    v_add_u32 v250, s61, v250
    v_xor_b32 v251, s60, v251
    v_add_u32 v251, s61, v251
    v_xor_b32 v252, s60, v252
    v_add_u32 v252, s61, v252
    v_xor_b32 v253, s60, v253
    v_add_u32 v253, s61, v253
    s_waitcnt lgkmcnt(0)
    s_setprio 3
    s_barrier
    ds_read_b64_tr_b16 v[164:165], v18 offset:0
    ds_read_b64_tr_b16 v[166:167], v19 offset:0
    ds_read_b64_tr_b16 v[168:169], v16 offset:16384
    ds_read_b64_tr_b16 v[170:171], v17 offset:16384
    ds_read_b64_tr_b16 v[172:173], v18 offset:1024
    ds_read_b64_tr_b16 v[174:175], v19 offset:1024
    ds_read_b64_tr_b16 v[176:177], v16 offset:17408
    ds_read_b64_tr_b16 v[178:179], v17 offset:17408
    ds_read_b64_tr_b16 v[180:181], v18 offset:2048
    ds_read_b64_tr_b16 v[182:183], v19 offset:2048
    ds_read_b64_tr_b16 v[184:185], v16 offset:18432
    ds_read_b64_tr_b16 v[186:187], v17 offset:18432
    s_waitcnt lgkmcnt(8)
    v_mfma_f32_32x32x16_bf16 v[64:79], v[164:167], v[168:171], 0
    ds_read_b64_tr_b16 v[188:189], v18 offset:3072
    ds_read_b64_tr_b16 v[190:191], v19 offset:3072
    ds_read_b64_tr_b16 v[192:193], v16 offset:19456
    ds_read_b64_tr_b16 v[194:195], v17 offset:19456
    s_waitcnt lgkmcnt(8)
    v_mfma_f32_32x32x16_bf16 v[64:79], v[172:175], v[176:179], v[64:79]
    ds_read_b64_tr_b16 v[196:197], v18 offset:4096
    ds_read_b64_tr_b16 v[198:199], v19 offset:4096
    ds_read_b64_tr_b16 v[200:201], v16 offset:20480
    ds_read_b64_tr_b16 v[202:203], v17 offset:20480
    s_waitcnt lgkmcnt(8)
    v_mfma_f32_32x32x16_bf16 v[64:79], v[180:183], v[184:187], v[64:79]
    ds_read_b64_tr_b16 v[204:205], v18 offset:5120
    ds_read_b64_tr_b16 v[206:207], v19 offset:5120
    ds_read_b64_tr_b16 v[208:209], v16 offset:21504
    ds_read_b64_tr_b16 v[210:211], v17 offset:21504
    s_waitcnt lgkmcnt(8)
    v_mfma_f32_32x32x16_bf16 v[64:79], v[188:191], v[192:195], v[64:79]
    ds_read_b64_tr_b16 v[212:213], v18 offset:6144
    ds_read_b64_tr_b16 v[214:215], v19 offset:6144
    ds_read_b64_tr_b16 v[216:217], v16 offset:22528
    ds_read_b64_tr_b16 v[218:219], v17 offset:22528
    s_waitcnt lgkmcnt(8)
    v_mfma_f32_32x32x16_bf16 v[64:79], v[196:199], v[200:203], v[64:79]
    ds_read_b64_tr_b16 v[220:221], v18 offset:7168
    ds_read_b64_tr_b16 v[222:223], v19 offset:7168
    ds_read_b64_tr_b16 v[224:225], v16 offset:23552
    ds_read_b64_tr_b16 v[226:227], v17 offset:23552
    s_waitcnt lgkmcnt(8)
    v_mfma_f32_32x32x16_bf16 v[64:79], v[204:207], v[208:211], v[64:79]
    s_waitcnt lgkmcnt(4)
    v_mfma_f32_32x32x16_bf16 v[64:79], v[212:215], v[216:219], v[64:79]
    s_waitcnt lgkmcnt(0)
    v_mfma_f32_32x32x16_bf16 v[64:79], v[220:223], v[224:227], v[64:79]
    s_nop 11
    v_cvt_pk_bf16_f32 v100, v64, v65
    v_cvt_pk_bf16_f32 v101, v66, v67
    v_cvt_pk_bf16_f32 v102, v68, v69
    v_cvt_pk_bf16_f32 v103, v70, v21
    buffer_store_dwordx4 v[100:103], v10, s[40:43], s62 offen sc1
    v_cvt_pk_bf16_f32 v104, v72, v73
    v_cvt_pk_bf16_f32 v105, v74, v75
    v_cvt_pk_bf16_f32 v106, v76, v77
    v_cvt_pk_bf16_f32 v107, v78, v21
    buffer_store_dwordx4 v[104:107], v10, s[40:43], s62 offen offset:1024 sc1
    s_waitcnt vmcnt(8)
    s_cmp_eq_u32 s7, 0
    s_cbranch_scc1 var_23
    s_waitcnt vmcnt(7)
var_23:
    s_mov_b64 exec, 1
    ds_add_u32 v2, v3 offset:24
    s_mov_b64 exec, -1
    s_waitcnt vmcnt(6)
    s_cmp_eq_u32 s7, 0
    s_cbranch_scc1 var_24
    s_waitcnt vmcnt(5)
var_24:
    s_mov_b64 exec, 1
    ds_add_u32 v2, v3 offset:28
    s_mov_b64 exec, -1
    s_waitcnt vmcnt(5)
    s_cmp_eq_u32 s7, 0
    s_cbranch_scc1 var_25
    s_waitcnt vmcnt(4)
var_25:
    s_mov_b64 exec, 1
    ds_add_u32 v2, v3 offset:32
    s_mov_b64 exec, -1
    s_waitcnt vmcnt(0)
    s_mov_b64 exec, 1
    ds_add_u32 v2, v3 offset:60
    s_mov_b64 exec, -1
    s_branch akv2_22
akv_21:
    v_lshrrev_b32 v4, 3, v1
    v_mul_u32_u24 v4, 896, v4
    v_bfe_u32 v5, v1, 4, 1
    v_lshlrev_b32 v5, 2, v5
    v_and_b32 v6, 7, v1
    v_xor_b32 v5, v5, v6
    v_lshl_add_u32 v13, v5, 4, v4
    s_mul_i32 s62, s55, 200704
    s_lshl_b32 s63, s54, 7
    s_add_u32 s62, s62, s63
    s_cmp_ge_u32 s45, 14
    s_cselect_b32 s62, 0x7f000000, s62
    s_mul_i32 s65, s55, 28672
    s_add_u32 s65, s65, 100352
    s_lshr_b32 s61, s2, 7
    s_lshl_b32 s61, s61, 1
    s_add_u32 s61, s61, s53
    s_waitcnt lgkmcnt(0)
    s_barrier
    s_waitcnt vmcnt(4)
    s_cmp_eq_u32 s7, 0
    s_cbranch_scc1 var_26
    s_waitcnt vmcnt(3)
var_26:
    s_mov_b64 exec, 1
    ds_add_u32 v2, v3 offset:24
    s_mov_b64 exec, -1
    s_waitcnt vmcnt(2)
    s_cmp_eq_u32 s7, 0
    s_cbranch_scc1 var_27
    s_waitcnt vmcnt(1)
var_27:
    s_mov_b64 exec, 1
    ds_add_u32 v2, v3 offset:28
    s_mov_b64 exec, -1
    s_waitcnt vmcnt(1)
    s_cmp_eq_u32 s7, 0
    s_cbranch_scc1 var_28
    s_waitcnt vmcnt(0)
var_28:
    s_mov_b64 exec, 1
    ds_add_u32 v2, v3 offset:32
    s_mov_b64 exec, -1
    s_add_u32 s60, s61, 0
    s_and_b32 s60, s60, 3
    s_mul_i32 s63, s60, 7168
    s_add_u32 s63, s63, s65
    s_mul_i32 s60, s60, 50176
    s_add_u32 s60, s60, s62
    s_add_u32 m0, s63, 0
    s_nop 0
    buffer_load_dwordx4 v13, s[20:23], s60 offen lds
    s_add_u32 m0, s63, 1024
    s_add_u32 s60, s60, 7168
    buffer_load_dwordx4 v13, s[20:23], s60 offen lds
    s_add_u32 m0, s63, 2048
    s_add_u32 s60, s60, 7168
    buffer_load_dwordx4 v13, s[20:23], s60 offen lds
    s_add_u32 m0, s63, 3072
    s_add_u32 s60, s60, 7168
    buffer_load_dwordx4 v13, s[20:23], s60 offen lds
    s_add_u32 m0, s63, 4096
    s_add_u32 s60, s60, 7168
    buffer_load_dwordx4 v13, s[20:23], s60 offen lds
    s_add_u32 m0, s63, 5120
    s_add_u32 s60, s60, 7168
    buffer_load_dwordx4 v13, s[20:23], s60 offen lds
    s_add_u32 m0, s63, 6144
    s_add_u32 s60, s60, 7168
    buffer_load_dwordx4 v13, s[20:23], s60 offen lds
    s_add_u32 s60, s61, 1
    s_and_b32 s60, s60, 3
    s_mul_i32 s63, s60, 7168
    s_add_u32 s63, s63, s65
    s_mul_i32 s60, s60, 50176
    s_add_u32 s60, s60, s62
    s_add_u32 m0, s63, 0
    s_nop 0
    buffer_load_dwordx4 v13, s[20:23], s60 offen lds
    s_add_u32 m0, s63, 1024
    s_add_u32 s60, s60, 7168
    buffer_load_dwordx4 v13, s[20:23], s60 offen lds
    s_add_u32 m0, s63, 2048
    s_add_u32 s60, s60, 7168
    buffer_load_dwordx4 v13, s[20:23], s60 offen lds
    s_add_u32 m0, s63, 3072
    s_add_u32 s60, s60, 7168
    buffer_load_dwordx4 v13, s[20:23], s60 offen lds
    s_add_u32 m0, s63, 4096
    s_add_u32 s60, s60, 7168
    buffer_load_dwordx4 v13, s[20:23], s60 offen lds
    s_add_u32 m0, s63, 5120
    s_add_u32 s60, s60, 7168
    buffer_load_dwordx4 v13, s[20:23], s60 offen lds
    s_add_u32 m0, s63, 6144
    s_add_u32 s60, s60, 7168
    buffer_load_dwordx4 v13, s[20:23], s60 offen lds
    s_add_u32 s60, s61, 2
    s_and_b32 s60, s60, 3
    s_mul_i32 s63, s60, 7168
    s_add_u32 s63, s63, s65
    s_mul_i32 s60, s60, 50176
    s_add_u32 s60, s60, s62
    s_add_u32 m0, s63, 0
    s_nop 0
    buffer_load_dwordx4 v13, s[20:23], s60 offen lds
    s_add_u32 m0, s63, 1024
    s_add_u32 s60, s60, 7168
    buffer_load_dwordx4 v13, s[20:23], s60 offen lds
    s_add_u32 m0, s63, 2048
    s_add_u32 s60, s60, 7168
    buffer_load_dwordx4 v13, s[20:23], s60 offen lds
    s_add_u32 m0, s63, 3072
    s_add_u32 s60, s60, 7168
    buffer_load_dwordx4 v13, s[20:23], s60 offen lds
    s_add_u32 m0, s63, 4096
    s_add_u32 s60, s60, 7168
    buffer_load_dwordx4 v13, s[20:23], s60 offen lds
    s_add_u32 m0, s63, 5120
    s_add_u32 s60, s60, 7168
    buffer_load_dwordx4 v13, s[20:23], s60 offen lds
    s_add_u32 m0, s63, 6144
    s_add_u32 s60, s60, 7168
    buffer_load_dwordx4 v13, s[20:23], s60 offen lds
    s_add_u32 s60, s61, 3
    s_and_b32 s60, s60, 3
    s_mul_i32 s63, s60, 7168
    s_add_u32 s63, s63, s65
    s_mul_i32 s60, s60, 50176
    s_add_u32 s60, s60, s62
    s_add_u32 m0, s63, 0
    s_nop 0
    buffer_load_dwordx4 v13, s[20:23], s60 offen lds
    s_add_u32 m0, s63, 1024
    s_add_u32 s60, s60, 7168
    buffer_load_dwordx4 v13, s[20:23], s60 offen lds
    s_add_u32 m0, s63, 2048
    s_add_u32 s60, s60, 7168
    buffer_load_dwordx4 v13, s[20:23], s60 offen lds
    s_add_u32 m0, s63, 3072
    s_add_u32 s60, s60, 7168
    buffer_load_dwordx4 v13, s[20:23], s60 offen lds
    s_add_u32 m0, s63, 4096
    s_add_u32 s60, s60, 7168
    buffer_load_dwordx4 v13, s[20:23], s60 offen lds
    s_add_u32 m0, s63, 5120
    s_add_u32 s60, s60, 7168
    buffer_load_dwordx4 v13, s[20:23], s60 offen lds
    s_add_u32 m0, s63, 6144
    s_add_u32 s60, s60, 7168
    buffer_load_dwordx4 v13, s[20:23], s60 offen lds
    buffer_load_dwordx4 v[240:243], v12, s[8:11], s79 offen offset:0
    buffer_load_dwordx4 v[244:247], v12, s[8:11], s79 offen offset:32
    s_lshl_b32 s72, s51, 15
    s_lshl_b32 s60, s56, 13
    s_add_u32 s72, s72, s60
    s_add_u32 s72, s72, 2097152
    s_cmp_ge_u32 s45, 14
    s_cbranch_scc1 anw_29
    v_lshrrev_b32 v5, 4, v1
    v_lshlrev_b32 v6, 2, v5
    v_and_b32 v4, 15, v1
    v_xor_b32 v4, v4, v6
    v_mul_u32_u24 v5, 3584, v5
    v_lshl_add_u32 v15, v4, 4, v5
    s_lshl_b32 s60, s45, 8
    v_add_u32 v15, s60, v15
    s_lshl_b32 s68, s55, 2
    s_lshr_b32 s68, 0x54, s68
    s_and_b32 s68, s68, 15
    s_lshl_b32 s67, s68, 13
    s_add_u32 s66, s68, s52
    s_cmp_ge_u32 s66, 14
    s_cselect_b32 s60, 14, 0
    s_sub_u32 s66, s66, s60
    s_mul_i32 s66, s66, 114688
    s_add_u32 m0, s67, 0
    s_nop 0
    buffer_load_dwordx4 v15, s[24:27], s66 offen lds
    s_add_u32 m0, s67, 1024
    s_add_u32 s66, s66, 14336
    buffer_load_dwordx4 v15, s[24:27], s66 offen lds
    s_add_u32 m0, s67, 2048
    s_add_u32 s66, s66, 14336
    buffer_load_dwordx4 v15, s[24:27], s66 offen lds
    s_add_u32 m0, s67, 3072
    s_add_u32 s66, s66, 14336
    buffer_load_dwordx4 v15, s[24:27], s66 offen lds
    s_add_u32 m0, s67, 4096
    s_add_u32 s66, s66, 14336
    buffer_load_dwordx4 v15, s[24:27], s66 offen lds
    s_add_u32 m0, s67, 5120
    s_add_u32 s66, s66, 14336
    buffer_load_dwordx4 v15, s[24:27], s66 offen lds
    s_add_u32 m0, s67, 6144
    s_add_u32 s66, s66, 14336
    buffer_load_dwordx4 v15, s[24:27], s66 offen lds
    s_add_u32 m0, s67, 7168
    s_add_u32 s66, s66, 14336
    buffer_load_dwordx4 v15, s[24:27], s66 offen lds
anw_29:
    v_lshrrev_b32 v4, 5, v1
    v_bfe_u32 v7, v1, 2, 2
    v_lshl_add_u32 v14, v4, 3, v7
    v_bfe_u32 v5, v1, 4, 1
    v_lshlrev_b32 v5, 1, v5
    v_bfe_u32 v6, v1, 1, 1
    v_or_b32 v5, v5, v6
    v_bfe_u32 v6, v14, 1, 1
    v_lshlrev_b32 v6, 2, v6
    v_xor_b32 v5, v5, v6
    v_lshlrev_b32 v5, 4, v5
    v_and_b32 v6, 1, v1
    v_lshl_add_u32 v5, v6, 3, v5
    v_lshl_add_u32 v248, v14, 7, v5
    v_xor_b32 v249, 64, v248
    v_lshrrev_b32 v4, 5, v1
    v_mul_u32_u24 v4, 3, v4
    v_bfe_u32 v7, v1, 2, 2
    v_min_u32 v7, 2, v7
    v_add3_u32 v4, v4, v7, 0
    v_lshrrev_b32 v7, 2, v4
    v_and_b32 v4, 3, v4
    v_lshl_add_u32 v14, v7, 3, v4
    v_add_u32 v14, 4, v14
    v_bfe_u32 v5, v1, 4, 1
    v_lshlrev_b32 v5, 1, v5
    v_bfe_u32 v6, v1, 1, 1
    v_or_b32 v5, v5, v6
    v_bfe_u32 v6, v14, 1, 1
    v_lshlrev_b32 v6, 2, v6
    v_xor_b32 v5, v5, v6
    v_lshlrev_b32 v5, 4, v5
    v_and_b32 v6, 1, v1
    v_lshl_add_u32 v5, v6, 3, v5
    v_lshl_add_u32 v250, v14, 7, v5
    v_xor_b32 v251, 64, v250
    v_lshrrev_b32 v4, 5, v1
    v_mul_u32_u24 v4, 3, v4
    v_bfe_u32 v7, v1, 2, 2
    v_min_u32 v7, 2, v7
    v_add3_u32 v4, v4, v7, 6
    v_lshrrev_b32 v7, 2, v4
    v_and_b32 v4, 3, v4
    v_lshl_add_u32 v14, v7, 3, v4
    v_add_u32 v14, 4, v14
    v_bfe_u32 v5, v1, 4, 1
    v_lshlrev_b32 v5, 1, v5
    v_bfe_u32 v6, v1, 1, 1
    v_or_b32 v5, v5, v6
    v_bfe_u32 v6, v14, 1, 1
    v_lshlrev_b32 v6, 2, v6
    v_xor_b32 v5, v5, v6
    v_lshlrev_b32 v5, 4, v5
    v_and_b32 v6, 1, v1
    v_lshl_add_u32 v5, v6, 3, v5
    v_lshl_add_u32 v252, v14, 7, v5
    v_xor_b32 v253, 64, v252
    s_lshl_b32 s60, s56, 6
    s_mul_i32 s61, s56, 28672
    s_add_u32 s61, s61, 100352
    v_xor_b32 v248, s60, v248
    v_add_u32 v248, s61, v248
    v_xor_b32 v249, s60, v249
    v_add_u32 v249, s61, v249
    v_xor_b32 v250, s60, v250
    v_add_u32 v250, s61, v250
    v_xor_b32 v251, s60, v251
    v_add_u32 v251, s61, v251
    v_xor_b32 v252, s60, v252
    v_add_u32 v252, s61, v252
    v_xor_b32 v253, s60, v253
    v_add_u32 v253, s61, v253
    s_mov_b32 s59, 0
cw_30:
    ds_read_b32 v4, v2 offset:60
    s_add_u32 s59, s59, 1
    s_lshr_b32 s3, s59, 20
    s_waitcnt lgkmcnt(0)
    v_readfirstlane_b32 s60, v4
    s_nop 0
    s_max_u32 s60, s60, s3
    s_cmp_lt_u32 s60, 1
    s_cbranch_scc1 cw_30
akv2_22:
    s_setprio 2
    s_mov_b32 s58, 15
    s_mov_b32 s57, 65536
    s_add_u32 s60, s64, 0
    s_and_b32 s60, s60, 0xffff
    s_add_u32 s60, s60, s76
    buffer_load_dwordx4 v[16:19], v10, s[40:43], s60 offen sc1
    s_add_u32 s60, s64, 4096
    s_and_b32 s60, s60, 0xffff
    s_add_u32 s60, s60, s76
    buffer_load_dwordx4 v[20:23], v10, s[40:43], s60 offen sc1
    s_add_u32 s60, s64, 8192
    s_and_b32 s60, s60, 0xffff
    s_add_u32 s60, s60, s76
    buffer_load_dwordx4 v[24:27], v10, s[40:43], s60 offen sc1
    s_add_u32 s60, s64, 12288
    s_and_b32 s60, s60, 0xffff
    s_add_u32 s60, s60, s76
    buffer_load_dwordx4 v[28:31], v10, s[40:43], s60 offen sc1
    s_add_u32 s60, s64, 16384
    s_and_b32 s60, s60, 0xffff
    s_add_u32 s60, s60, s76
    buffer_load_dwordx4 v[32:35], v10, s[40:43], s60 offen sc1
    s_add_u32 s60, s64, 20480
    s_and_b32 s60, s60, 0xffff
    s_add_u32 s60, s60, s76
    buffer_load_dwordx4 v[36:39], v10, s[40:43], s60 offen sc1
    s_add_u32 s60, s64, 24576
    s_and_b32 s60, s60, 0xffff
    s_add_u32 s60, s60, s76
    buffer_load_dwordx4 v[40:43], v10, s[40:43], s60 offen sc1
    s_add_u32 s60, s64, 28672
    s_and_b32 s60, s60, 0xffff
    s_add_u32 s60, s60, s76
    buffer_load_dwordx4 v[44:47], v10, s[40:43], s60 offen sc1
    s_add_u32 s60, s64, 32768
    s_and_b32 s60, s60, 0xffff
    s_add_u32 s60, s60, s76
    buffer_load_dwordx4 v[48:51], v10, s[40:43], s60 offen sc1
    s_add_u32 s60, s64, 36864
    s_and_b32 s60, s60, 0xffff
    s_add_u32 s60, s60, s76
    buffer_load_dwordx4 v[52:55], v10, s[40:43], s60 offen sc1
    s_add_u32 s60, s64, 40960
    s_and_b32 s60, s60, 0xffff
    s_add_u32 s60, s60, s76
    buffer_load_dwordx4 v[56:59], v10, s[40:43], s60 offen sc1
    s_add_u32 s60, s64, 45056
    s_and_b32 s60, s60, 0xffff
    s_add_u32 s60, s60, s76
    buffer_load_dwordx4 v[60:63], v10, s[40:43], s60 offen sc1
    s_waitcnt vmcnt(8)
    v_xor_b32 v8, v11, v19
    v_bitop3_b32 v8, v8, v11, v23 bitop3:0xf6
    v_bitop3_b32 v8, v8, v11, v27 bitop3:0xf6
    v_bitop3_b32 v8, v8, v11, v31 bitop3:0xf6
    v_cmp_lt_u32 vcc, 0xffff, v8
    s_cbranch_vccnz tg_33
    v_dot2c_f32_bf16 v144, s74, v16
    v_dot2c_f32_bf16 v145, s75, v16
    v_dot2c_f32_bf16 v146, s74, v17
    v_dot2c_f32_bf16 v147, s75, v17
    v_dot2c_f32_bf16 v148, s74, v18
    v_dot2c_f32_bf16 v149, s75, v18
    v_dot2c_f32_bf16 v150, s74, v19
    v_dot2c_f32_bf16 v144, s74, v20
    v_dot2c_f32_bf16 v145, s75, v20
    v_dot2c_f32_bf16 v146, s74, v21
    v_dot2c_f32_bf16 v147, s75, v21
    v_dot2c_f32_bf16 v148, s74, v22
    v_dot2c_f32_bf16 v149, s75, v22
    v_dot2c_f32_bf16 v150, s74, v23
    v_dot2c_f32_bf16 v144, s74, v24
    v_dot2c_f32_bf16 v145, s75, v24
    v_dot2c_f32_bf16 v146, s74, v25
    v_dot2c_f32_bf16 v147, s75, v25
    v_dot2c_f32_bf16 v148, s74, v26
    v_dot2c_f32_bf16 v149, s75, v26
    v_dot2c_f32_bf16 v150, s74, v27
    v_dot2c_f32_bf16 v144, s74, v28
    v_dot2c_f32_bf16 v145, s75, v28
    v_dot2c_f32_bf16 v146, s74, v29
    v_dot2c_f32_bf16 v147, s75, v29
    v_dot2c_f32_bf16 v148, s74, v30
    v_dot2c_f32_bf16 v149, s75, v30
    v_dot2c_f32_bf16 v150, s74, v31
    s_bitset0_b32 s58, 0
tg_33:
    s_add_u32 s60, s64, 49152
    s_and_b32 s60, s60, 0xffff
    s_add_u32 s60, s60, s76
    buffer_load_dwordx4 v[64:67], v10, s[40:43], s60 offen sc1
    s_add_u32 s60, s64, 53248
    s_and_b32 s60, s60, 0xffff
    s_add_u32 s60, s60, s76
    buffer_load_dwordx4 v[68:71], v10, s[40:43], s60 offen sc1
    s_add_u32 s60, s64, 57344
    s_and_b32 s60, s60, 0xffff
    s_add_u32 s60, s60, s76
    buffer_load_dwordx4 v[72:75], v10, s[40:43], s60 offen sc1
    s_add_u32 s60, s64, 61440
    s_and_b32 s60, s60, 0xffff
    s_add_u32 s60, s60, s76
    buffer_load_dwordx4 v[76:79], v10, s[40:43], s60 offen sc1
    s_mov_b64 exec, 1
    ds_add_u32 v2, v3 offset:108
    s_mov_b64 exec, -1
    s_waitcnt vmcnt(8)
    v_xor_b32 v8, v11, v35
    v_bitop3_b32 v8, v8, v11, v39 bitop3:0xf6
    v_bitop3_b32 v8, v8, v11, v43 bitop3:0xf6
    v_bitop3_b32 v8, v8, v11, v47 bitop3:0xf6
    v_cmp_lt_u32 vcc, 0xffff, v8
    s_cbranch_vccnz tg_34
    v_dot2c_f32_bf16 v144, s74, v32
    v_dot2c_f32_bf16 v145, s75, v32
    v_dot2c_f32_bf16 v146, s74, v33
    v_dot2c_f32_bf16 v147, s75, v33
    v_dot2c_f32_bf16 v148, s74, v34
    v_dot2c_f32_bf16 v149, s75, v34
    v_dot2c_f32_bf16 v150, s74, v35
    v_dot2c_f32_bf16 v144, s74, v36
    v_dot2c_f32_bf16 v145, s75, v36
    v_dot2c_f32_bf16 v146, s74, v37
    v_dot2c_f32_bf16 v147, s75, v37
    v_dot2c_f32_bf16 v148, s74, v38
    v_dot2c_f32_bf16 v149, s75, v38
    v_dot2c_f32_bf16 v150, s74, v39
    v_dot2c_f32_bf16 v144, s74, v40
    v_dot2c_f32_bf16 v145, s75, v40
    v_dot2c_f32_bf16 v146, s74, v41
    v_dot2c_f32_bf16 v147, s75, v41
    v_dot2c_f32_bf16 v148, s74, v42
    v_dot2c_f32_bf16 v149, s75, v42
    v_dot2c_f32_bf16 v150, s74, v43
    v_dot2c_f32_bf16 v144, s74, v44
    v_dot2c_f32_bf16 v145, s75, v44
    v_dot2c_f32_bf16 v146, s74, v45
    v_dot2c_f32_bf16 v147, s75, v45
    v_dot2c_f32_bf16 v148, s74, v46
    v_dot2c_f32_bf16 v149, s75, v46
    v_dot2c_f32_bf16 v150, s74, v47
    s_bitset0_b32 s58, 1
tg_34:
    s_waitcnt vmcnt(4)
    v_xor_b32 v8, v11, v51
    v_bitop3_b32 v8, v8, v11, v55 bitop3:0xf6
    v_bitop3_b32 v8, v8, v11, v59 bitop3:0xf6
    v_bitop3_b32 v8, v8, v11, v63 bitop3:0xf6
    v_cmp_lt_u32 vcc, 0xffff, v8
    s_cbranch_vccnz tg_35
    v_dot2c_f32_bf16 v144, s74, v48
    v_dot2c_f32_bf16 v145, s75, v48
    v_dot2c_f32_bf16 v146, s74, v49
    v_dot2c_f32_bf16 v147, s75, v49
    v_dot2c_f32_bf16 v148, s74, v50
    v_dot2c_f32_bf16 v149, s75, v50
    v_dot2c_f32_bf16 v150, s74, v51
    v_dot2c_f32_bf16 v144, s74, v52
    v_dot2c_f32_bf16 v145, s75, v52
    v_dot2c_f32_bf16 v146, s74, v53
    v_dot2c_f32_bf16 v147, s75, v53
    v_dot2c_f32_bf16 v148, s74, v54
    v_dot2c_f32_bf16 v149, s75, v54
    v_dot2c_f32_bf16 v150, s74, v55
    v_dot2c_f32_bf16 v144, s74, v56
    v_dot2c_f32_bf16 v145, s75, v56
    v_dot2c_f32_bf16 v146, s74, v57
    v_dot2c_f32_bf16 v147, s75, v57
    v_dot2c_f32_bf16 v148, s74, v58
    v_dot2c_f32_bf16 v149, s75, v58
    v_dot2c_f32_bf16 v150, s74, v59
    v_dot2c_f32_bf16 v144, s74, v60
    v_dot2c_f32_bf16 v145, s75, v60
    v_dot2c_f32_bf16 v146, s74, v61
    v_dot2c_f32_bf16 v147, s75, v61
    v_dot2c_f32_bf16 v148, s74, v62
    v_dot2c_f32_bf16 v149, s75, v62
    v_dot2c_f32_bf16 v150, s74, v63
    s_bitset0_b32 s58, 2
tg_35:
    s_waitcnt vmcnt(0)
    v_xor_b32 v8, v11, v67
    v_bitop3_b32 v8, v8, v11, v71 bitop3:0xf6
    v_bitop3_b32 v8, v8, v11, v75 bitop3:0xf6
    v_bitop3_b32 v8, v8, v11, v79 bitop3:0xf6
    v_cmp_lt_u32 vcc, 0xffff, v8
    s_cbranch_vccnz tg_36
    v_dot2c_f32_bf16 v144, s74, v64
    v_dot2c_f32_bf16 v145, s75, v64
    v_dot2c_f32_bf16 v146, s74, v65
    v_dot2c_f32_bf16 v147, s75, v65
    v_dot2c_f32_bf16 v148, s74, v66
    v_dot2c_f32_bf16 v149, s75, v66
    v_dot2c_f32_bf16 v150, s74, v67
    v_dot2c_f32_bf16 v144, s74, v68
    v_dot2c_f32_bf16 v145, s75, v68
    v_dot2c_f32_bf16 v146, s74, v69
    v_dot2c_f32_bf16 v147, s75, v69
    v_dot2c_f32_bf16 v148, s74, v70
    v_dot2c_f32_bf16 v149, s75, v70
    v_dot2c_f32_bf16 v150, s74, v71
    v_dot2c_f32_bf16 v144, s74, v72
    v_dot2c_f32_bf16 v145, s75, v72
    v_dot2c_f32_bf16 v146, s74, v73
    v_dot2c_f32_bf16 v147, s75, v73
    v_dot2c_f32_bf16 v148, s74, v74
    v_dot2c_f32_bf16 v149, s75, v74
    v_dot2c_f32_bf16 v150, s74, v75
    v_dot2c_f32_bf16 v144, s74, v76
    v_dot2c_f32_bf16 v145, s75, v76
    v_dot2c_f32_bf16 v146, s74, v77
    v_dot2c_f32_bf16 v147, s75, v77
    v_dot2c_f32_bf16 v148, s74, v78
    v_dot2c_f32_bf16 v149, s75, v78
    v_dot2c_f32_bf16 v150, s74, v79
    s_bitset0_b32 s58, 3
tg_36:
tgl_31:
    s_cmp_eq_u32 s58, 0
    s_cbranch_scc1 tgd_32
    s_bitcmp1_b32 s58, 0
    s_cbranch_scc0 ti_37
    s_add_u32 s60, s64, 0
    s_and_b32 s60, s60, 0xffff
    s_add_u32 s60, s60, s76
    buffer_load_dwordx4 v[16:19], v10, s[40:43], s60 offen sc1
    s_add_u32 s60, s64, 4096
    s_and_b32 s60, s60, 0xffff
    s_add_u32 s60, s60, s76
    buffer_load_dwordx4 v[20:23], v10, s[40:43], s60 offen sc1
    s_add_u32 s60, s64, 8192
    s_and_b32 s60, s60, 0xffff
    s_add_u32 s60, s60, s76
    buffer_load_dwordx4 v[24:27], v10, s[40:43], s60 offen sc1
    s_add_u32 s60, s64, 12288
    s_and_b32 s60, s60, 0xffff
    s_add_u32 s60, s60, s76
    buffer_load_dwordx4 v[28:31], v10, s[40:43], s60 offen sc1
ti_37:
    s_bitcmp1_b32 s58, 1
    s_cbranch_scc0 ti_38
    s_add_u32 s60, s64, 16384
    s_and_b32 s60, s60, 0xffff
    s_add_u32 s60, s60, s76
    buffer_load_dwordx4 v[32:35], v10, s[40:43], s60 offen sc1
    s_add_u32 s60, s64, 20480
    s_and_b32 s60, s60, 0xffff
    s_add_u32 s60, s60, s76
    buffer_load_dwordx4 v[36:39], v10, s[40:43], s60 offen sc1
    s_add_u32 s60, s64, 24576
    s_and_b32 s60, s60, 0xffff
    s_add_u32 s60, s60, s76
    buffer_load_dwordx4 v[40:43], v10, s[40:43], s60 offen sc1
    s_add_u32 s60, s64, 28672
    s_and_b32 s60, s60, 0xffff
    s_add_u32 s60, s60, s76
    buffer_load_dwordx4 v[44:47], v10, s[40:43], s60 offen sc1
ti_38:
    s_bitcmp1_b32 s58, 2
    s_cbranch_scc0 ti_39
    s_add_u32 s60, s64, 32768
    s_and_b32 s60, s60, 0xffff
    s_add_u32 s60, s60, s76
    buffer_load_dwordx4 v[48:51], v10, s[40:43], s60 offen sc1
    s_add_u32 s60, s64, 36864
    s_and_b32 s60, s60, 0xffff
    s_add_u32 s60, s60, s76
    buffer_load_dwordx4 v[52:55], v10, s[40:43], s60 offen sc1
    s_add_u32 s60, s64, 40960
    s_and_b32 s60, s60, 0xffff
    s_add_u32 s60, s60, s76
    buffer_load_dwordx4 v[56:59], v10, s[40:43], s60 offen sc1
    s_add_u32 s60, s64, 45056
    s_and_b32 s60, s60, 0xffff
    s_add_u32 s60, s60, s76
    buffer_load_dwordx4 v[60:63], v10, s[40:43], s60 offen sc1
ti_39:
    s_bitcmp1_b32 s58, 3
    s_cbranch_scc0 ti_40
    s_add_u32 s60, s64, 49152
    s_and_b32 s60, s60, 0xffff
    s_add_u32 s60, s60, s76
    buffer_load_dwordx4 v[64:67], v10, s[40:43], s60 offen sc1
    s_add_u32 s60, s64, 53248
    s_and_b32 s60, s60, 0xffff
    s_add_u32 s60, s60, s76
    buffer_load_dwordx4 v[68:71], v10, s[40:43], s60 offen sc1
    s_add_u32 s60, s64, 57344
    s_and_b32 s60, s60, 0xffff
    s_add_u32 s60, s60, s76
    buffer_load_dwordx4 v[72:75], v10, s[40:43], s60 offen sc1
    s_add_u32 s60, s64, 61440
    s_and_b32 s60, s60, 0xffff
    s_add_u32 s60, s60, s76
    buffer_load_dwordx4 v[76:79], v10, s[40:43], s60 offen sc1
ti_40:
    s_waitcnt vmcnt(0)
    s_bitcmp1_b32 s58, 0
    s_cbranch_scc0 tc_41
    v_xor_b32 v8, v11, v19
    v_bitop3_b32 v8, v8, v11, v23 bitop3:0xf6
    v_bitop3_b32 v8, v8, v11, v27 bitop3:0xf6
    v_bitop3_b32 v8, v8, v11, v31 bitop3:0xf6
    v_cmp_lt_u32 vcc, 0xffff, v8
    s_cbranch_vccnz tg_42
    v_dot2c_f32_bf16 v144, s74, v16
    v_dot2c_f32_bf16 v145, s75, v16
    v_dot2c_f32_bf16 v146, s74, v17
    v_dot2c_f32_bf16 v147, s75, v17
    v_dot2c_f32_bf16 v148, s74, v18
    v_dot2c_f32_bf16 v149, s75, v18
    v_dot2c_f32_bf16 v150, s74, v19
    v_dot2c_f32_bf16 v144, s74, v20
    v_dot2c_f32_bf16 v145, s75, v20
    v_dot2c_f32_bf16 v146, s74, v21
    v_dot2c_f32_bf16 v147, s75, v21
    v_dot2c_f32_bf16 v148, s74, v22
    v_dot2c_f32_bf16 v149, s75, v22
    v_dot2c_f32_bf16 v150, s74, v23
    v_dot2c_f32_bf16 v144, s74, v24
    v_dot2c_f32_bf16 v145, s75, v24
    v_dot2c_f32_bf16 v146, s74, v25
    v_dot2c_f32_bf16 v147, s75, v25
    v_dot2c_f32_bf16 v148, s74, v26
    v_dot2c_f32_bf16 v149, s75, v26
    v_dot2c_f32_bf16 v150, s74, v27
    v_dot2c_f32_bf16 v144, s74, v28
    v_dot2c_f32_bf16 v145, s75, v28
    v_dot2c_f32_bf16 v146, s74, v29
    v_dot2c_f32_bf16 v147, s75, v29
    v_dot2c_f32_bf16 v148, s74, v30
    v_dot2c_f32_bf16 v149, s75, v30
    v_dot2c_f32_bf16 v150, s74, v31
    s_bitset0_b32 s58, 0
tg_42:
tc_41:
    s_bitcmp1_b32 s58, 1
    s_cbranch_scc0 tc_43
    v_xor_b32 v8, v11, v35
    v_bitop3_b32 v8, v8, v11, v39 bitop3:0xf6
    v_bitop3_b32 v8, v8, v11, v43 bitop3:0xf6
    v_bitop3_b32 v8, v8, v11, v47 bitop3:0xf6
    v_cmp_lt_u32 vcc, 0xffff, v8
    s_cbranch_vccnz tg_44
    v_dot2c_f32_bf16 v144, s74, v32
    v_dot2c_f32_bf16 v145, s75, v32
    v_dot2c_f32_bf16 v146, s74, v33
    v_dot2c_f32_bf16 v147, s75, v33
    v_dot2c_f32_bf16 v148, s74, v34
    v_dot2c_f32_bf16 v149, s75, v34
    v_dot2c_f32_bf16 v150, s74, v35
    v_dot2c_f32_bf16 v144, s74, v36
    v_dot2c_f32_bf16 v145, s75, v36
    v_dot2c_f32_bf16 v146, s74, v37
    v_dot2c_f32_bf16 v147, s75, v37
    v_dot2c_f32_bf16 v148, s74, v38
    v_dot2c_f32_bf16 v149, s75, v38
    v_dot2c_f32_bf16 v150, s74, v39
    v_dot2c_f32_bf16 v144, s74, v40
    v_dot2c_f32_bf16 v145, s75, v40
    v_dot2c_f32_bf16 v146, s74, v41
    v_dot2c_f32_bf16 v147, s75, v41
    v_dot2c_f32_bf16 v148, s74, v42
    v_dot2c_f32_bf16 v149, s75, v42
    v_dot2c_f32_bf16 v150, s74, v43
    v_dot2c_f32_bf16 v144, s74, v44
    v_dot2c_f32_bf16 v145, s75, v44
    v_dot2c_f32_bf16 v146, s74, v45
    v_dot2c_f32_bf16 v147, s75, v45
    v_dot2c_f32_bf16 v148, s74, v46
    v_dot2c_f32_bf16 v149, s75, v46
    v_dot2c_f32_bf16 v150, s74, v47
    s_bitset0_b32 s58, 1
tg_44:
tc_43:
    s_bitcmp1_b32 s58, 2
    s_cbranch_scc0 tc_45
    v_xor_b32 v8, v11, v51
    v_bitop3_b32 v8, v8, v11, v55 bitop3:0xf6
    v_bitop3_b32 v8, v8, v11, v59 bitop3:0xf6
    v_bitop3_b32 v8, v8, v11, v63 bitop3:0xf6
    v_cmp_lt_u32 vcc, 0xffff, v8
    s_cbranch_vccnz tg_46
    v_dot2c_f32_bf16 v144, s74, v48
    v_dot2c_f32_bf16 v145, s75, v48
    v_dot2c_f32_bf16 v146, s74, v49
    v_dot2c_f32_bf16 v147, s75, v49
    v_dot2c_f32_bf16 v148, s74, v50
    v_dot2c_f32_bf16 v149, s75, v50
    v_dot2c_f32_bf16 v150, s74, v51
    v_dot2c_f32_bf16 v144, s74, v52
    v_dot2c_f32_bf16 v145, s75, v52
    v_dot2c_f32_bf16 v146, s74, v53
    v_dot2c_f32_bf16 v147, s75, v53
    v_dot2c_f32_bf16 v148, s74, v54
    v_dot2c_f32_bf16 v149, s75, v54
    v_dot2c_f32_bf16 v150, s74, v55
    v_dot2c_f32_bf16 v144, s74, v56
    v_dot2c_f32_bf16 v145, s75, v56
    v_dot2c_f32_bf16 v146, s74, v57
    v_dot2c_f32_bf16 v147, s75, v57
    v_dot2c_f32_bf16 v148, s74, v58
    v_dot2c_f32_bf16 v149, s75, v58
    v_dot2c_f32_bf16 v150, s74, v59
    v_dot2c_f32_bf16 v144, s74, v60
    v_dot2c_f32_bf16 v145, s75, v60
    v_dot2c_f32_bf16 v146, s74, v61
    v_dot2c_f32_bf16 v147, s75, v61
    v_dot2c_f32_bf16 v148, s74, v62
    v_dot2c_f32_bf16 v149, s75, v62
    v_dot2c_f32_bf16 v150, s74, v63
    s_bitset0_b32 s58, 2
tg_46:
tc_45:
    s_bitcmp1_b32 s58, 3
    s_cbranch_scc0 tc_47
    v_xor_b32 v8, v11, v67
    v_bitop3_b32 v8, v8, v11, v71 bitop3:0xf6
    v_bitop3_b32 v8, v8, v11, v75 bitop3:0xf6
    v_bitop3_b32 v8, v8, v11, v79 bitop3:0xf6
    v_cmp_lt_u32 vcc, 0xffff, v8
    s_cbranch_vccnz tg_48
    v_dot2c_f32_bf16 v144, s74, v64
    v_dot2c_f32_bf16 v145, s75, v64
    v_dot2c_f32_bf16 v146, s74, v65
    v_dot2c_f32_bf16 v147, s75, v65
    v_dot2c_f32_bf16 v148, s74, v66
    v_dot2c_f32_bf16 v149, s75, v66
    v_dot2c_f32_bf16 v150, s74, v67
    v_dot2c_f32_bf16 v144, s74, v68
    v_dot2c_f32_bf16 v145, s75, v68
    v_dot2c_f32_bf16 v146, s74, v69
    v_dot2c_f32_bf16 v147, s75, v69
    v_dot2c_f32_bf16 v148, s74, v70
    v_dot2c_f32_bf16 v149, s75, v70
    v_dot2c_f32_bf16 v150, s74, v71
    v_dot2c_f32_bf16 v144, s74, v72
    v_dot2c_f32_bf16 v145, s75, v72
    v_dot2c_f32_bf16 v146, s74, v73
    v_dot2c_f32_bf16 v147, s75, v73
    v_dot2c_f32_bf16 v148, s74, v74
    v_dot2c_f32_bf16 v149, s75, v74
    v_dot2c_f32_bf16 v150, s74, v75
    v_dot2c_f32_bf16 v144, s74, v76
    v_dot2c_f32_bf16 v145, s75, v76
    v_dot2c_f32_bf16 v146, s74, v77
    v_dot2c_f32_bf16 v147, s75, v77
    v_dot2c_f32_bf16 v148, s74, v78
    v_dot2c_f32_bf16 v149, s75, v78
    v_dot2c_f32_bf16 v150, s74, v79
    s_bitset0_b32 s58, 3
tg_48:
tc_47:
    s_sub_u32 s57, s57, 1
    s_cbranch_scc0 tgl_31
tgd_32:
    v_cvt_pk_bf16_f32 v152, v144, v145
    v_cvt_pk_bf16_f32 v153, v146, v147
    v_cvt_pk_bf16_f32 v154, v148, v149
    v_cvt_pk_bf16_f32 v155, v150, 0
    ds_write_b128 v9, v[152:155]
    s_waitcnt lgkmcnt(0)
    s_mov_b64 exec, 1
    ds_add_u32 v2, v3 offset:12
    s_mov_b64 exec, -1
    s_setprio 1
    v_permlane32_swap_b32 v240, v242
    v_permlane32_swap_b32 v241, v243
    v_permlane32_swap_b32 v244, v246
    v_permlane32_swap_b32 v245, v247
    v_lshlrev_b32 v208, 16, v240
    v_and_b32 v209, 0xffff0000, v240
    v_lshlrev_b32 v210, 16, v241
    v_and_b32 v211, 0xffff0000, v241
    v_lshlrev_b32 v212, 16, v242
    v_and_b32 v213, 0xffff0000, v242
    v_lshlrev_b32 v214, 16, v243
    v_and_b32 v215, 0xffff0000, v243
    v_lshlrev_b32 v216, 16, v244
    v_and_b32 v217, 0xffff0000, v244
    v_lshlrev_b32 v218, 16, v245
    v_and_b32 v219, 0xffff0000, v245
    v_lshlrev_b32 v220, 16, v246
    v_and_b32 v221, 0xffff0000, v246
    v_lshlrev_b32 v222, 16, v247
    v_and_b32 v223, 0xffff0000, v247
    v_mov_b32 v224, 0
    v_mov_b32 v225, 0
    v_mov_b32 v226, 0
    v_mov_b32 v227, 0
    v_mov_b32 v228, 0
    v_mov_b32 v229, 0
    v_mov_b32 v230, 0
    v_mov_b32 v231, 0
    v_mov_b32 v232, 0
    v_mov_b32 v233, 0
    v_mov_b32 v234, 0
    v_mov_b32 v235, 0
    v_mov_b32 v236, 0
    v_mov_b32 v237, 0
    v_mov_b32 v238, 0
    v_mov_b32 v239, 0
    s_mov_b32 s59, 0
cw_50:
    ds_read_b32 v4, v2 offset:12
    s_add_u32 s59, s59, 1
    s_lshr_b32 s3, s59, 20
    s_waitcnt lgkmcnt(0)
    v_readfirstlane_b32 s60, v4
    s_nop 0
    s_max_u32 s60, s60, s3
    s_cmp_lt_u32 s60, 4
    s_cbranch_scc1 cw_50
    s_cmp_ge_u32 s45, 14
    s_cbranch_scc1 anf_49
    ds_read_b64_tr_b16 v[16:17], v248 offset:0
    ds_read_b64_tr_b16 v[18:19], v250 offset:0
    ds_read_b64_tr_b16 v[20:21], v249 offset:0
    ds_read_b64_tr_b16 v[22:23], v251 offset:0
    ds_read_b64_tr_b16 v[24:25], v248 offset:2048
    ds_read_b64_tr_b16 v[26:27], v252 offset:0
    ds_read_b64_tr_b16 v[28:29], v249 offset:2048
    ds_read_b64_tr_b16 v[30:31], v253 offset:0
    ds_read_b64_tr_b16 v[32:33], v248 offset:3584
    ds_read_b64_tr_b16 v[34:35], v250 offset:3584
    ds_read_b64_tr_b16 v[36:37], v249 offset:3584
    ds_read_b64_tr_b16 v[38:39], v251 offset:3584
    ds_read_b64_tr_b16 v[40:41], v248 offset:5632
    ds_read_b64_tr_b16 v[42:43], v252 offset:3584
    ds_read_b64_tr_b16 v[44:45], v249 offset:5632
    s_waitcnt lgkmcnt(12)
    ds_read_b64_tr_b16 v[46:47], v253 offset:3584
    ds_read_b64_tr_b16 v[48:49], v248 offset:7168
    ds_read_b64_tr_b16 v[50:51], v250 offset:7168
    s_waitcnt lgkmcnt(12)
    ds_read_b64_tr_b16 v[52:53], v249 offset:7168
    ds_read_b64_tr_b16 v[54:55], v251 offset:7168
    ds_read_b64_tr_b16 v[56:57], v248 offset:9216
    s_waitcnt lgkmcnt(12)
    ds_read_b64_tr_b16 v[58:59], v252 offset:7168
    ds_read_b64_tr_b16 v[60:61], v249 offset:9216
    ds_read_b64_tr_b16 v[62:63], v253 offset:7168
    s_waitcnt lgkmcnt(12)
    ds_read_b64_tr_b16 v[64:65], v248 offset:10752
    ds_read_b64_tr_b16 v[66:67], v250 offset:10752
    ds_read_b64_tr_b16 v[68:69], v249 offset:10752
    s_waitcnt lgkmcnt(12)
    ds_read_b64_tr_b16 v[70:71], v251 offset:10752
    ds_read_b64_tr_b16 v[72:73], v248 offset:12800
    ds_read_b64_tr_b16 v[74:75], v252 offset:10752
    s_waitcnt lgkmcnt(12)
    ds_read_b64_tr_b16 v[76:77], v249 offset:12800
    ds_read_b64_tr_b16 v[78:79], v253 offset:10752
    ds_read_b64_tr_b16 v[80:81], v248 offset:14336
    s_waitcnt lgkmcnt(12)
    ds_read_b64_tr_b16 v[82:83], v250 offset:14336
    ds_read_b64_tr_b16 v[84:85], v249 offset:14336
    ds_read_b64_tr_b16 v[86:87], v251 offset:14336
    s_waitcnt lgkmcnt(12)
    ds_read_b64_tr_b16 v[88:89], v248 offset:16384
    ds_read_b64_tr_b16 v[90:91], v252 offset:14336
    ds_read_b64_tr_b16 v[92:93], v249 offset:16384
    s_waitcnt lgkmcnt(12)
    ds_read_b64_tr_b16 v[94:95], v253 offset:14336
    ds_read_b64_tr_b16 v[96:97], v248 offset:17920
    ds_read_b64_tr_b16 v[98:99], v250 offset:17920
    s_waitcnt lgkmcnt(12)
    ds_read_b64_tr_b16 v[100:101], v249 offset:17920
    ds_read_b64_tr_b16 v[102:103], v251 offset:17920
    ds_read_b64_tr_b16 v[104:105], v248 offset:19968
    s_waitcnt lgkmcnt(12)
    ds_read_b64_tr_b16 v[106:107], v252 offset:17920
    ds_read_b64_tr_b16 v[108:109], v249 offset:19968
    ds_read_b64_tr_b16 v[110:111], v253 offset:17920
    s_waitcnt lgkmcnt(12)
    ds_read_b64_tr_b16 v[112:113], v248 offset:21504
    ds_read_b64_tr_b16 v[114:115], v250 offset:21504
    ds_read_b64_tr_b16 v[116:117], v249 offset:21504
    s_waitcnt lgkmcnt(12)
    ds_read_b64_tr_b16 v[118:119], v251 offset:21504
    ds_read_b64_tr_b16 v[120:121], v248 offset:23552
    ds_read_b64_tr_b16 v[122:123], v252 offset:21504
    s_waitcnt lgkmcnt(12)
    ds_read_b64_tr_b16 v[124:125], v249 offset:23552
    ds_read_b64_tr_b16 v[126:127], v253 offset:21504
    ds_read_b64_tr_b16 v[128:129], v248 offset:25088
    s_waitcnt lgkmcnt(12)
    ds_read_b64_tr_b16 v[130:131], v250 offset:25088
    ds_read_b64_tr_b16 v[132:133], v249 offset:25088
    ds_read_b64_tr_b16 v[134:135], v251 offset:25088
    s_waitcnt lgkmcnt(12)
    ds_read_b64_tr_b16 v[136:137], v248 offset:27136
    ds_read_b64_tr_b16 v[138:139], v252 offset:25088
    ds_read_b64_tr_b16 v[140:141], v249 offset:27136
    s_waitcnt lgkmcnt(12)
    ds_read_b64_tr_b16 v[142:143], v253 offset:25088
anf_49:
    s_mov_b32 s71, 0x7f000000
    s_cmp_ge_u32 s45, 14
    s_cbranch_scc1 ano2_52
    v_bfe_u32 v8, v1, 4, 1
    v_mul_u32_u24 v8, 16384, v8
    v_lshrrev_b32 v5, 5, v1
    v_lshl_add_u32 v8, v5, 8, v8
    v_and_b32 v5, 15, v1
    v_lshl_add_u32 v8, v5, 4, v8
    v_mov_b32 v9, s50
    s_lshl_b32 s62, s51, 15
    s_lshl_b32 s63, s56, 13
    s_add_u32 s62, s62, s63
    s_add_u32 s62, s62, 2097152
    s_add_u32 s63, s62, 4096
    v_lshlrev_b32 v10, 4, v1
    s_lshl_b32 s60, s47, 12
    s_add_u32 s61, s60, 114688
    s_xor_b32 s60, s60, 0x2000
    s_add_u32 s60, s60, 114688
    v_add_u32 v11, s60, v10
    v_add_u32 v10, s61, v10
    s_lshl_b32 s60, s55, 2
    v_add_u32 v255, s60, v2
    v_bfe_u32 v12, v1, 4, 1
    v_mul_u32_u24 v12, 14336, v12
    v_lshrrev_b32 v5, 5, v1
    v_lshl_add_u32 v12, v5, 8, v12
    v_and_b32 v5, 15, v1
    v_lshl_add_u32 v12, v5, 4, v12
    v_and_b32 v13, 31, v1
    v_lshlrev_b32 v13, 3, v13
    s_lshl_b32 s64, s54, 1
    s_add_u32 s64, s64, s56
    s_mul_i32 s76, s51, 28672
    s_lshl_b32 s60, s64, 10
    s_add_u32 s76, s76, s60
    s_add_u32 s76, s76, 4210688
    s_lshl_b32 s77, s51, 12
    s_lshl_b32 s60, s64, 8
    s_add_u32 s77, s77, s60
    s_add_u32 s77, s77, 65536
    s_lshl_b32 s65, s51, 7
    s_lshl_b32 s64, s64, 2
    s_add_u32 s65, s65, s64
    s_waitcnt lgkmcnt(0)
    s_mov_b64 exec, 1
    ds_add_u32 v2, v3 offset:4
    s_mov_b64 exec, -1
    v_and_b32 v15, 7, v1
    v_lshlrev_b32 v15, 10, v15
    v_add_u32 v15, 16384, v15
    s_mov_b32 s59, 0
cw_53:
    ds_read_b32 v4, v2 offset:4
    s_add_u32 s59, s59, 1
    s_lshr_b32 s3, s59, 20
    s_waitcnt lgkmcnt(0)
    v_readfirstlane_b32 s60, v4
    s_nop 0
    s_max_u32 s60, s60, s3
    s_cmp_lt_u32 s60, 4
    s_cbranch_scc1 cw_53
    s_mov_b32 s59, 0
cw_54:
    ds_read_b32 v4, v2 offset:16
    s_add_u32 s59, s59, 1
    s_lshr_b32 s3, s59, 20
    s_waitcnt lgkmcnt(0)
    v_readfirstlane_b32 s60, v4
    s_nop 0
    s_max_u32 s60, s60, s3
    s_cmp_lt_u32 s60, 4
    s_cbranch_scc1 cw_54
    s_sleep 4
    s_mov_b32 s58, 255
    s_mov_b32 s57, 65536
    buffer_load_dwordx4 v[144:147], v8, s[40:43], s62 offen offset:0 sc1
    buffer_load_dwordx4 v[148:151], v8, s[40:43], s62 offen offset:512 sc1
    buffer_load_dwordx4 v[152:155], v8, s[40:43], s62 offen offset:1024 sc1
    buffer_load_dwordx4 v[156:159], v8, s[40:43], s62 offen offset:1536 sc1
    buffer_load_dwordx4 v[160:163], v8, s[40:43], s62 offen offset:2048 sc1
    buffer_load_dwordx4 v[164:167], v8, s[40:43], s62 offen offset:2560 sc1
    buffer_load_dwordx4 v[168:171], v8, s[40:43], s62 offen offset:3072 sc1
    buffer_load_dwordx4 v[172:175], v8, s[40:43], s62 offen offset:3584 sc1
    buffer_load_dwordx4 v[176:179], v8, s[40:43], s63 offen offset:0 sc1
    buffer_load_dwordx4 v[180:183], v8, s[40:43], s63 offen offset:512 sc1
    buffer_load_dwordx4 v[184:187], v8, s[40:43], s63 offen offset:1024 sc1
    buffer_load_dwordx4 v[188:191], v8, s[40:43], s63 offen offset:1536 sc1
    buffer_load_dwordx4 v[192:195], v8, s[40:43], s63 offen offset:2048 sc1
    buffer_load_dwordx4 v[196:199], v8, s[40:43], s63 offen offset:2560 sc1
    buffer_load_dwordx4 v[200:203], v8, s[40:43], s63 offen offset:3072 sc1
    buffer_load_dwordx4 v[204:207], v8, s[40:43], s63 offen offset:3584 sc1
    s_mov_b64 exec, 1
    ds_add_u32 v2, v3 offset:56
    s_mov_b64 exec, -1
    s_waitcnt vmcnt(14)
    v_xor_b32 v14, v9, v147
    v_bitop3_b32 v14, v14, v9, v151 bitop3:0xf6
    v_cmp_lt_u32 vcc, 0xffff, v14
    s_cbranch_vccnz tg_57
    v_and_b32 v147, 0xffff, v147
    v_and_b32 v151, 0xffff, v151
    s_nop 0
    v_mfma_f32_32x32x16_bf16 v[224:239], v[20:23], v[144:147], v[224:239]
    v_mfma_f32_32x32x16_bf16 v[224:239], v[28:31], v[148:151], v[224:239]
    v_mfma_f32_32x32x16_bf16 v[208:223], v[16:19], v[144:147], v[208:223]
    v_mfma_f32_32x32x16_bf16 v[208:223], v[24:27], v[148:151], v[208:223]
    s_bitset0_b32 s58, 0
tg_57:
    s_waitcnt vmcnt(12)
    v_xor_b32 v14, v9, v155
    v_bitop3_b32 v14, v14, v9, v159 bitop3:0xf6
    v_cmp_lt_u32 vcc, 0xffff, v14
    s_cbranch_vccnz tg_58
    v_and_b32 v155, 0xffff, v155
    v_and_b32 v159, 0xffff, v159
    s_nop 0
    v_mfma_f32_32x32x16_bf16 v[224:239], v[36:39], v[152:155], v[224:239]
    v_mfma_f32_32x32x16_bf16 v[224:239], v[44:47], v[156:159], v[224:239]
    v_mfma_f32_32x32x16_bf16 v[208:223], v[32:35], v[152:155], v[208:223]
    v_mfma_f32_32x32x16_bf16 v[208:223], v[40:43], v[156:159], v[208:223]
    s_bitset0_b32 s58, 1
tg_58:
    s_waitcnt vmcnt(10)
    v_xor_b32 v14, v9, v163
    v_bitop3_b32 v14, v14, v9, v167 bitop3:0xf6
    v_cmp_lt_u32 vcc, 0xffff, v14
    s_cbranch_vccnz tg_59
    v_and_b32 v163, 0xffff, v163
    v_and_b32 v167, 0xffff, v167
    s_nop 0
    v_mfma_f32_32x32x16_bf16 v[224:239], v[52:55], v[160:163], v[224:239]
    v_mfma_f32_32x32x16_bf16 v[224:239], v[60:63], v[164:167], v[224:239]
    v_mfma_f32_32x32x16_bf16 v[208:223], v[48:51], v[160:163], v[208:223]
    v_mfma_f32_32x32x16_bf16 v[208:223], v[56:59], v[164:167], v[208:223]
    s_bitset0_b32 s58, 2
tg_59:
    s_waitcnt vmcnt(8)
    v_xor_b32 v14, v9, v171
    v_bitop3_b32 v14, v14, v9, v175 bitop3:0xf6
    v_cmp_lt_u32 vcc, 0xffff, v14
    s_cbranch_vccnz tg_60
    v_and_b32 v171, 0xffff, v171
    v_and_b32 v175, 0xffff, v175
    s_nop 0
    v_mfma_f32_32x32x16_bf16 v[224:239], v[68:71], v[168:171], v[224:239]
    v_mfma_f32_32x32x16_bf16 v[224:239], v[76:79], v[172:175], v[224:239]
    v_mfma_f32_32x32x16_bf16 v[208:223], v[64:67], v[168:171], v[208:223]
    v_mfma_f32_32x32x16_bf16 v[208:223], v[72:75], v[172:175], v[208:223]
    s_bitset0_b32 s58, 3
tg_60:
    s_waitcnt vmcnt(6)
    v_xor_b32 v14, v9, v179
    v_bitop3_b32 v14, v14, v9, v183 bitop3:0xf6
    v_cmp_lt_u32 vcc, 0xffff, v14
    s_cbranch_vccnz tg_61
    v_and_b32 v179, 0xffff, v179
    v_and_b32 v183, 0xffff, v183
    s_nop 0
    v_mfma_f32_32x32x16_bf16 v[224:239], v[84:87], v[176:179], v[224:239]
    v_mfma_f32_32x32x16_bf16 v[224:239], v[92:95], v[180:183], v[224:239]
    v_mfma_f32_32x32x16_bf16 v[208:223], v[80:83], v[176:179], v[208:223]
    v_mfma_f32_32x32x16_bf16 v[208:223], v[88:91], v[180:183], v[208:223]
    s_bitset0_b32 s58, 4
tg_61:
    s_waitcnt vmcnt(4)
    v_xor_b32 v14, v9, v187
    v_bitop3_b32 v14, v14, v9, v191 bitop3:0xf6
    v_cmp_lt_u32 vcc, 0xffff, v14
    s_cbranch_vccnz tg_62
    v_and_b32 v187, 0xffff, v187
    v_and_b32 v191, 0xffff, v191
    s_nop 0
    v_mfma_f32_32x32x16_bf16 v[224:239], v[100:103], v[184:187], v[224:239]
    v_mfma_f32_32x32x16_bf16 v[224:239], v[108:111], v[188:191], v[224:239]
    v_mfma_f32_32x32x16_bf16 v[208:223], v[96:99], v[184:187], v[208:223]
    v_mfma_f32_32x32x16_bf16 v[208:223], v[104:107], v[188:191], v[208:223]
    s_bitset0_b32 s58, 5
tg_62:
    s_waitcnt vmcnt(2)
    v_xor_b32 v14, v9, v195
    v_bitop3_b32 v14, v14, v9, v199 bitop3:0xf6
    v_cmp_lt_u32 vcc, 0xffff, v14
    s_cbranch_vccnz tg_63
    v_and_b32 v195, 0xffff, v195
    v_and_b32 v199, 0xffff, v199
    s_nop 0
    v_mfma_f32_32x32x16_bf16 v[224:239], v[116:119], v[192:195], v[224:239]
    v_mfma_f32_32x32x16_bf16 v[224:239], v[124:127], v[196:199], v[224:239]
    v_mfma_f32_32x32x16_bf16 v[208:223], v[112:115], v[192:195], v[208:223]
    v_mfma_f32_32x32x16_bf16 v[208:223], v[120:123], v[196:199], v[208:223]
    s_bitset0_b32 s58, 6
tg_63:
    s_waitcnt vmcnt(0)
    v_xor_b32 v14, v9, v203
    v_bitop3_b32 v14, v14, v9, v207 bitop3:0xf6
    v_cmp_lt_u32 vcc, 0xffff, v14
    s_cbranch_vccnz tg_64
    v_and_b32 v203, 0xffff, v203
    v_and_b32 v207, 0xffff, v207
    s_nop 0
    v_mfma_f32_32x32x16_bf16 v[224:239], v[132:135], v[200:203], v[224:239]
    v_mfma_f32_32x32x16_bf16 v[224:239], v[140:143], v[204:207], v[224:239]
    v_mfma_f32_32x32x16_bf16 v[208:223], v[128:131], v[200:203], v[208:223]
    v_mfma_f32_32x32x16_bf16 v[208:223], v[136:139], v[204:207], v[208:223]
    s_bitset0_b32 s58, 7
tg_64:
tgl_55:
    s_cmp_eq_u32 s58, 0
    s_cbranch_scc1 tgd_56
    s_bitcmp1_b32 s58, 0
    s_cbranch_scc0 ti_65
    buffer_load_dwordx4 v[144:147], v8, s[40:43], s62 offen offset:0 sc1
    buffer_load_dwordx4 v[148:151], v8, s[40:43], s62 offen offset:512 sc1
ti_65:
    s_bitcmp1_b32 s58, 1
    s_cbranch_scc0 ti_66
    buffer_load_dwordx4 v[152:155], v8, s[40:43], s62 offen offset:1024 sc1
    buffer_load_dwordx4 v[156:159], v8, s[40:43], s62 offen offset:1536 sc1
ti_66:
    s_bitcmp1_b32 s58, 2
    s_cbranch_scc0 ti_67
    buffer_load_dwordx4 v[160:163], v8, s[40:43], s62 offen offset:2048 sc1
    buffer_load_dwordx4 v[164:167], v8, s[40:43], s62 offen offset:2560 sc1
ti_67:
    s_bitcmp1_b32 s58, 3
    s_cbranch_scc0 ti_68
    buffer_load_dwordx4 v[168:171], v8, s[40:43], s62 offen offset:3072 sc1
    buffer_load_dwordx4 v[172:175], v8, s[40:43], s62 offen offset:3584 sc1
ti_68:
    s_bitcmp1_b32 s58, 4
    s_cbranch_scc0 ti_69
    buffer_load_dwordx4 v[176:179], v8, s[40:43], s63 offen offset:0 sc1
    buffer_load_dwordx4 v[180:183], v8, s[40:43], s63 offen offset:512 sc1
ti_69:
    s_bitcmp1_b32 s58, 5
    s_cbranch_scc0 ti_70
    buffer_load_dwordx4 v[184:187], v8, s[40:43], s63 offen offset:1024 sc1
    buffer_load_dwordx4 v[188:191], v8, s[40:43], s63 offen offset:1536 sc1
ti_70:
    s_bitcmp1_b32 s58, 6
    s_cbranch_scc0 ti_71
    buffer_load_dwordx4 v[192:195], v8, s[40:43], s63 offen offset:2048 sc1
    buffer_load_dwordx4 v[196:199], v8, s[40:43], s63 offen offset:2560 sc1
ti_71:
    s_bitcmp1_b32 s58, 7
    s_cbranch_scc0 ti_72
    buffer_load_dwordx4 v[200:203], v8, s[40:43], s63 offen offset:3072 sc1
    buffer_load_dwordx4 v[204:207], v8, s[40:43], s63 offen offset:3584 sc1
ti_72:
    s_waitcnt vmcnt(0)
    s_bitcmp1_b32 s58, 0
    s_cbranch_scc0 tc_73
    v_xor_b32 v14, v9, v147
    v_bitop3_b32 v14, v14, v9, v151 bitop3:0xf6
    v_cmp_lt_u32 vcc, 0xffff, v14
    s_cbranch_vccnz tg_74
    v_and_b32 v147, 0xffff, v147
    v_and_b32 v151, 0xffff, v151
    s_nop 0
    v_mfma_f32_32x32x16_bf16 v[224:239], v[20:23], v[144:147], v[224:239]
    v_mfma_f32_32x32x16_bf16 v[224:239], v[28:31], v[148:151], v[224:239]
    v_mfma_f32_32x32x16_bf16 v[208:223], v[16:19], v[144:147], v[208:223]
    v_mfma_f32_32x32x16_bf16 v[208:223], v[24:27], v[148:151], v[208:223]
    s_bitset0_b32 s58, 0
tg_74:
tc_73:
    s_bitcmp1_b32 s58, 1
    s_cbranch_scc0 tc_75
    v_xor_b32 v14, v9, v155
    v_bitop3_b32 v14, v14, v9, v159 bitop3:0xf6
    v_cmp_lt_u32 vcc, 0xffff, v14
    s_cbranch_vccnz tg_76
    v_and_b32 v155, 0xffff, v155
    v_and_b32 v159, 0xffff, v159
    s_nop 0
    v_mfma_f32_32x32x16_bf16 v[224:239], v[36:39], v[152:155], v[224:239]
    v_mfma_f32_32x32x16_bf16 v[224:239], v[44:47], v[156:159], v[224:239]
    v_mfma_f32_32x32x16_bf16 v[208:223], v[32:35], v[152:155], v[208:223]
    v_mfma_f32_32x32x16_bf16 v[208:223], v[40:43], v[156:159], v[208:223]
    s_bitset0_b32 s58, 1
tg_76:
tc_75:
    s_bitcmp1_b32 s58, 2
    s_cbranch_scc0 tc_77
    v_xor_b32 v14, v9, v163
    v_bitop3_b32 v14, v14, v9, v167 bitop3:0xf6
    v_cmp_lt_u32 vcc, 0xffff, v14
    s_cbranch_vccnz tg_78
    v_and_b32 v163, 0xffff, v163
    v_and_b32 v167, 0xffff, v167
    s_nop 0
    v_mfma_f32_32x32x16_bf16 v[224:239], v[52:55], v[160:163], v[224:239]
    v_mfma_f32_32x32x16_bf16 v[224:239], v[60:63], v[164:167], v[224:239]
    v_mfma_f32_32x32x16_bf16 v[208:223], v[48:51], v[160:163], v[208:223]
    v_mfma_f32_32x32x16_bf16 v[208:223], v[56:59], v[164:167], v[208:223]
    s_bitset0_b32 s58, 2
tg_78:
tc_77:
    s_bitcmp1_b32 s58, 3
    s_cbranch_scc0 tc_79
    v_xor_b32 v14, v9, v171
    v_bitop3_b32 v14, v14, v9, v175 bitop3:0xf6
    v_cmp_lt_u32 vcc, 0xffff, v14
    s_cbranch_vccnz tg_80
    v_and_b32 v171, 0xffff, v171
    v_and_b32 v175, 0xffff, v175
    s_nop 0
    v_mfma_f32_32x32x16_bf16 v[224:239], v[68:71], v[168:171], v[224:239]
    v_mfma_f32_32x32x16_bf16 v[224:239], v[76:79], v[172:175], v[224:239]
    v_mfma_f32_32x32x16_bf16 v[208:223], v[64:67], v[168:171], v[208:223]
    v_mfma_f32_32x32x16_bf16 v[208:223], v[72:75], v[172:175], v[208:223]
    s_bitset0_b32 s58, 3
tg_80:
tc_79:
    s_bitcmp1_b32 s58, 4
    s_cbranch_scc0 tc_81
    v_xor_b32 v14, v9, v179
    v_bitop3_b32 v14, v14, v9, v183 bitop3:0xf6
    v_cmp_lt_u32 vcc, 0xffff, v14
    s_cbranch_vccnz tg_82
    v_and_b32 v179, 0xffff, v179
    v_and_b32 v183, 0xffff, v183
    s_nop 0
    v_mfma_f32_32x32x16_bf16 v[224:239], v[84:87], v[176:179], v[224:239]
    v_mfma_f32_32x32x16_bf16 v[224:239], v[92:95], v[180:183], v[224:239]
    v_mfma_f32_32x32x16_bf16 v[208:223], v[80:83], v[176:179], v[208:223]
    v_mfma_f32_32x32x16_bf16 v[208:223], v[88:91], v[180:183], v[208:223]
    s_bitset0_b32 s58, 4
tg_82:
tc_81:
    s_bitcmp1_b32 s58, 5
    s_cbranch_scc0 tc_83
    v_xor_b32 v14, v9, v187
    v_bitop3_b32 v14, v14, v9, v191 bitop3:0xf6
    v_cmp_lt_u32 vcc, 0xffff, v14
    s_cbranch_vccnz tg_84
    v_and_b32 v187, 0xffff, v187
    v_and_b32 v191, 0xffff, v191
    s_nop 0
    v_mfma_f32_32x32x16_bf16 v[224:239], v[100:103], v[184:187], v[224:239]
    v_mfma_f32_32x32x16_bf16 v[224:239], v[108:111], v[188:191], v[224:239]
    v_mfma_f32_32x32x16_bf16 v[208:223], v[96:99], v[184:187], v[208:223]
    v_mfma_f32_32x32x16_bf16 v[208:223], v[104:107], v[188:191], v[208:223]
    s_bitset0_b32 s58, 5
tg_84:
tc_83:
    s_bitcmp1_b32 s58, 6
    s_cbranch_scc0 tc_85
    v_xor_b32 v14, v9, v195
    v_bitop3_b32 v14, v14, v9, v199 bitop3:0xf6
    v_cmp_lt_u32 vcc, 0xffff, v14
    s_cbranch_vccnz tg_86
    v_and_b32 v195, 0xffff, v195
    v_and_b32 v199, 0xffff, v199
    s_nop 0
    v_mfma_f32_32x32x16_bf16 v[224:239], v[116:119], v[192:195], v[224:239]
    v_mfma_f32_32x32x16_bf16 v[224:239], v[124:127], v[196:199], v[224:239]
    v_mfma_f32_32x32x16_bf16 v[208:223], v[112:115], v[192:195], v[208:223]
    v_mfma_f32_32x32x16_bf16 v[208:223], v[120:123], v[196:199], v[208:223]
    s_bitset0_b32 s58, 6
tg_86:
tc_85:
    s_bitcmp1_b32 s58, 7
    s_cbranch_scc0 tc_87
    v_xor_b32 v14, v9, v203
    v_bitop3_b32 v14, v14, v9, v207 bitop3:0xf6
    v_cmp_lt_u32 vcc, 0xffff, v14
    s_cbranch_vccnz tg_88
    v_and_b32 v203, 0xffff, v203
    v_and_b32 v207, 0xffff, v207
    s_nop 0
    v_mfma_f32_32x32x16_bf16 v[224:239], v[132:135], v[200:203], v[224:239]
    v_mfma_f32_32x32x16_bf16 v[224:239], v[140:143], v[204:207], v[224:239]
    v_mfma_f32_32x32x16_bf16 v[208:223], v[128:131], v[200:203], v[208:223]
    v_mfma_f32_32x32x16_bf16 v[208:223], v[136:139], v[204:207], v[208:223]
    s_bitset0_b32 s58, 7
tg_88:
tc_87:
    s_sub_u32 s57, s57, 1
    s_cbranch_scc0 tgl_55
tgd_56:
    s_nop 6
    ds_write_b128 v10, v[224:227] offset:0
    ds_write_b128 v10, v[228:231] offset:1024
    ds_write_b128 v10, v[232:235] offset:2048
    ds_write_b128 v10, v[236:239] offset:3072
    s_waitcnt lgkmcnt(0)
    s_mov_b64 exec, 1
    ds_add_u32 v255, v3 offset:40
    s_mov_b64 exec, -1
    s_mov_b32 s59, 0
cw_89:
    ds_read_b32 v4, v255 offset:40
    s_add_u32 s59, s59, 1
    s_lshr_b32 s3, s59, 20
    s_waitcnt lgkmcnt(0)
    v_readfirstlane_b32 s60, v4
    s_nop 0
    s_max_u32 s60, s60, s3
    s_cmp_lt_u32 s60, 2
    s_cbranch_scc1 cw_89
    ds_read_b128 v[224:227], v11 offset:0
    ds_read_b128 v[228:231], v11 offset:1024
    ds_read_b128 v[232:235], v11 offset:2048
    ds_read_b128 v[236:239], v11 offset:3072
    v_mov_b32 v14, 0
    v_mov_b32 v15, 0
    s_waitcnt lgkmcnt(3)
    v_pk_add_f32 v[208:209], v[208:209], v[224:225]
    v_pk_add_f32 v[210:211], v[210:211], v[226:227]
    v_cvt_pk_bf16_f32 v240, v208, v209
    v_cvt_pk_bf16_f32 v241, v210, v211
    s_waitcnt lgkmcnt(2)
    v_pk_add_f32 v[212:213], v[212:213], v[228:229]
    v_pk_add_f32 v[214:215], v[214:215], v[230:231]
    v_cvt_pk_bf16_f32 v242, v212, v213
    v_cvt_pk_bf16_f32 v243, v214, v215
    buffer_store_dwordx4 v[240:243], v12, s[40:43], s76 offen offset:0 sc1
    s_waitcnt lgkmcnt(1)
    v_pk_add_f32 v[216:217], v[216:217], v[232:233]
    v_pk_add_f32 v[218:219], v[218:219], v[234:235]
    v_cvt_pk_bf16_f32 v244, v216, v217
    v_cvt_pk_bf16_f32 v245, v218, v219
    s_waitcnt lgkmcnt(0)
    v_pk_add_f32 v[220:221], v[220:221], v[236:237]
    v_pk_add_f32 v[222:223], v[222:223], v[238:239]
    v_cvt_pk_bf16_f32 v246, v220, v221
    v_cvt_pk_bf16_f32 v247, v222, v223
    buffer_store_dwordx4 v[244:247], v12, s[40:43], s76 offen offset:512 sc1
    v_dot2c_f32_bf16 v14, s73, v240
    v_dot2c_f32_bf16 v15, v240, v240
    v_dot2c_f32_bf16 v14, s73, v241
    v_dot2c_f32_bf16 v15, v241, v241
    v_dot2c_f32_bf16 v14, s73, v242
    v_dot2c_f32_bf16 v15, v242, v242
    v_dot2c_f32_bf16 v14, s73, v243
    v_dot2c_f32_bf16 v15, v243, v243
    v_dot2c_f32_bf16 v14, s73, v244
    v_dot2c_f32_bf16 v15, v244, v244
    v_dot2c_f32_bf16 v14, s73, v245
    v_dot2c_f32_bf16 v15, v245, v245
    v_dot2c_f32_bf16 v14, s73, v246
    v_dot2c_f32_bf16 v15, v246, v246
    v_dot2c_f32_bf16 v14, s73, v247
    v_dot2c_f32_bf16 v15, v247, v247
    s_nop 1
    v_mov_b32 v5, v14
    v_mov_b32 v6, v15
    s_nop 0
    v_permlane32_swap_b32 v14, v5
    v_permlane32_swap_b32 v15, v6
    v_add_f32 v14, v14, v5
    v_add_f32 v15, v15, v6
    buffer_store_dwordx2 v[14:15], v13, s[40:43], s77 offen sc1
    s_add_u32 s60, s65, 4096
    s_add_u32 s71, s65, 12288
    v_mov_b32 v5, 0
    v_mov_b32 v6, s48
    s_mov_b64 exec, 1
    s_waitcnt vmcnt(0)
    buffer_store_dword v6, v5, s[40:43], s60 offen
    s_mov_b64 exec, -1
    s_branch ano_51
ano2_52:
    s_lshr_b32 s60, s2, 7
    s_lshl_b32 s60, s60, 1
    s_add_u32 s60, s60, s45
    s_sub_u32 s60, s60, 14
    s_lshl_b32 s60, s60, 2
    s_add_u32 s60, s60, s47
    s_mul_i32 s62, s60, 7168
    v_lshlrev_b32 v7, 7, v1
    s_mov_b32 s59, 0
cw_90:
    s_sleep 1
    ds_read_b32 v4, v2 offset:16
    s_add_u32 s59, s59, 1
    s_lshr_b32 s3, s59, 20
    s_waitcnt lgkmcnt(0)
    v_readfirstlane_b32 s60, v4
    s_nop 0
    s_max_u32 s60, s60, s3
    s_cmp_lt_u32 s60, 4
    s_cbranch_scc1 cw_90
    s_mov_b32 exec_hi, 0xffffff
    s_add_u32 s61, s62, 0
    buffer_load_dword v254, v7, s[32:35], s61 offen
    s_waitcnt vmcnt(2)
    s_add_u32 s61, s62, 802816
    buffer_load_dword v254, v7, s[32:35], s61 offen
    s_waitcnt vmcnt(2)
    s_add_u32 s61, s62, 344064
    buffer_load_dword v254, v7, s[32:35], s61 offen
    s_waitcnt vmcnt(2)
    s_add_u32 s61, s62, 1146880
    buffer_load_dword v254, v7, s[32:35], s61 offen
    s_waitcnt vmcnt(2)
    s_add_u32 s61, s62, 114688
    buffer_load_dword v254, v7, s[32:35], s61 offen
    s_waitcnt vmcnt(2)
    s_add_u32 s61, s62, 917504
    buffer_load_dword v254, v7, s[32:35], s61 offen
    s_waitcnt vmcnt(2)
    s_add_u32 s61, s62, 458752
    buffer_load_dword v254, v7, s[32:35], s61 offen
    s_waitcnt vmcnt(2)
    s_add_u32 s61, s62, 1261568
    buffer_load_dword v254, v7, s[32:35], s61 offen
    s_waitcnt vmcnt(2)
    s_add_u32 s61, s62, 229376
    buffer_load_dword v254, v7, s[32:35], s61 offen
    s_waitcnt vmcnt(2)
    s_add_u32 s61, s62, 1032192
    buffer_load_dword v254, v7, s[32:35], s61 offen
    s_waitcnt vmcnt(2)
    s_add_u32 s61, s62, 573440
    buffer_load_dword v254, v7, s[32:35], s61 offen
    s_waitcnt vmcnt(2)
    s_add_u32 s61, s62, 1376256
    buffer_load_dword v254, v7, s[32:35], s61 offen
    s_waitcnt vmcnt(2)
    s_add_u32 s61, s62, 688128
    buffer_load_dword v254, v7, s[32:35], s61 offen
    s_waitcnt vmcnt(2)
    s_add_u32 s61, s62, 1490944
    buffer_load_dword v254, v7, s[32:35], s61 offen
    s_waitcnt vmcnt(2)
    s_mov_b32 exec_hi, -1
    s_branch L_Aexit
ano_51:
    v_lshrrev_b32 v4, 5, v1
    v_bfe_u32 v5, v1, 2, 2
    v_lshl_add_u32 v4, v4, 2, v5
    v_lshlrev_b32 v4, 8, v4
    v_lshl_add_u32 v4, v5, 6, v4
    v_bfe_u32 v5, v1, 4, 1
    v_lshl_add_u32 v4, v5, 5, v4
    v_and_b32 v5, 3, v1
    v_lshl_add_u32 v8, v5, 3, v4
    v_xor_b32 v9, 64, v8
    v_xor_b32 v10, 128, v8
    v_xor_b32 v11, 192, v8
    v_add_u32 v248, 57344, v8
    v_add_u32 v249, 57344, v9
    v_add_u32 v250, 57344, v10
    v_add_u32 v251, 57344, v11
    v_bfe_u32 v12, v1, 4, 1
    v_mul_u32_u24 v12, 14336, v12
    v_lshrrev_b32 v5, 5, v1
    v_lshl_add_u32 v12, v5, 8, v12
    v_and_b32 v5, 15, v1
    v_lshl_add_u32 v12, v5, 4, v12
    v_lshlrev_b32 v15, 4, v1
    v_add_u32 v15, 147456, v15
    v_min_u32 v13, 13, v1
    v_lshlrev_b32 v13, 2, v13
    v_lshrrev_b32 v4, 5, v1
    v_mul_u32_u24 v4, 1792, v4
    v_and_b32 v5, 31, v1
    v_lshl_add_u32 v14, v5, 3, v4
    s_lshl_b32 s76, s44, 2
    s_add_u32 s76, s76, s47
    s_mul_i32 s62, s76, 28672
    s_add_u32 s62, s62, 4210688
    s_lshl_b32 s63, s76, 12
    s_add_u32 s63, s63, 65536
    s_lshl_b32 s65, s76, 7
    s_lshl_b32 s101, s52, 10
    s_add_u32 s101, s101, s62
    s_add_u32 s64, s62, 14336
    s_mov_b32 s59, 0
cw_91:
    ds_read_b32 v4, v2 offset:20
    s_add_u32 s59, s59, 1
    s_lshr_b32 s3, s59, 20
    s_waitcnt lgkmcnt(0)
    v_readfirstlane_b32 s60, v4
    s_nop 0
    s_max_u32 s60, s60, s3
    s_cmp_lt_u32 s60, 4
    s_cbranch_scc1 cw_91
    ds_read_b64_tr_b16 v[80:81], v8 offset:0
    ds_read_b64_tr_b16 v[82:83], v8 offset:2048
    ds_read_b64_tr_b16 v[84:85], v9 offset:0
    ds_read_b64_tr_b16 v[86:87], v9 offset:2048
    ds_read_b64_tr_b16 v[88:89], v10 offset:0
    ds_read_b64_tr_b16 v[90:91], v10 offset:2048
    ds_read_b64_tr_b16 v[92:93], v8 offset:4096
    ds_read_b64_tr_b16 v[94:95], v8 offset:6144
    ds_read_b64_tr_b16 v[96:97], v9 offset:4096
    ds_read_b64_tr_b16 v[98:99], v9 offset:6144
    ds_read_b64_tr_b16 v[100:101], v10 offset:4096
    ds_read_b64_tr_b16 v[102:103], v10 offset:6144
    s_mov_b32 s57, 16384
    s_add_u32 s60, s65, 4096
    s_add_u32 s61, s65, 12288
pf_92:
    s_mov_b32 s3, 24
pfi_94:
    buffer_load_dword v4, v13, s[40:43], s60 offen sc1
    s_sub_u32 s3, s3, 1
    s_waitcnt vmcnt(0)
    v_cmp_ne_u32 vcc, s48, v4
    s_cbranch_vccz pfd_93
    s_cbranch_scc0 pfi_94
    v_mov_b32 v5, 0
    v_mov_b32 v6, s48
    s_mov_b64 exec, 1
    buffer_store_dword v6, v5, s[40:43], s71 offen sc1
    s_mov_b64 exec, -1
    s_mov_b32 s71, 0x7f000000
    buffer_load_dword v4, v13, s[40:43], s61 offen sc1
    s_waitcnt vmcnt(0)
    v_cmp_ne_u32 vcc, s48, v4
    s_cbranch_vccz pfd_93
    s_sub_u32 s57, s57, 1
    s_cbranch_scc0 pf_92
pfd_93:
    buffer_load_dwordx4 v[128:131], v12, s[40:43], s101 offen offset:0 sc1
    buffer_load_dwordx4 v[132:135], v12, s[40:43], s101 offen offset:512 sc1
    s_add_u32 s101, s101, 1024
    s_cmp_eq_u32 s101, s64
    s_cselect_b32 s101, s62, s101
    buffer_load_dwordx4 v[136:139], v12, s[40:43], s101 offen offset:0 sc1
    buffer_load_dwordx4 v[140:143], v12, s[40:43], s101 offen offset:512 sc1
    s_add_u32 s101, s101, 1024
    s_cmp_eq_u32 s101, s64
    s_cselect_b32 s101, s62, s101
    buffer_load_dwordx4 v[144:147], v12, s[40:43], s101 offen offset:0 sc1
    buffer_load_dwordx4 v[148:151], v12, s[40:43], s101 offen offset:512 sc1
    s_add_u32 s101, s101, 1024
    s_cmp_eq_u32 s101, s64
    s_cselect_b32 s101, s62, s101
    buffer_load_dwordx4 v[152:155], v12, s[40:43], s101 offen offset:0 sc1
    buffer_load_dwordx4 v[156:159], v12, s[40:43], s101 offen offset:512 sc1
    buffer_load_dwordx2 v[64:65], v14, s[40:43], s63 offen offset:0 sc1
    buffer_load_dwordx2 v[66:67], v14, s[40:43], s63 offen offset:256 sc1
    buffer_load_dwordx2 v[68:69], v14, s[40:43], s63 offen offset:512 sc1
    buffer_load_dwordx2 v[70:71], v14, s[40:43], s63 offen offset:768 sc1
    buffer_load_dwordx2 v[72:73], v14, s[40:43], s63 offen offset:1024 sc1
    buffer_load_dwordx2 v[74:75], v14, s[40:43], s63 offen offset:1280 sc1
    buffer_load_dwordx2 v[76:77], v14, s[40:43], s63 offen offset:1536 sc1
    v_bfe_u32 v13, v1, 4, 1
    v_mul_u32_u24 v13, 57344, v13
    v_lshrrev_b32 v5, 5, v1
    v_lshl_add_u32 v13, v5, 8, v13
    v_and_b32 v5, 15, v1
    v_lshl_add_u32 v13, v5, 4, v13
    s_mul_i32 s77, s47, 114688
    s_lshl_b32 s60, s44, 19
    s_add_u32 s77, s77, s60
    s_lshl_b32 s60, s45, 12
    s_add_u32 s77, s77, s60
    s_add_u32 s77, s77, 6291456
    s_lshl_b32 s60, s45, 2
    s_add_u32 s65, s65, s60
    s_waitcnt vmcnt(14)
    s_waitcnt lgkmcnt(10)
    v_mfma_f32_32x32x16_bf16 v[16:31], v[80:83], v[128:131], 0
    ds_read_b64_tr_b16 v[104:105], v8 offset:8192
    ds_read_b64_tr_b16 v[106:107], v8 offset:10240
    s_add_u32 s101, s101, 1024
    s_cmp_eq_u32 s101, s64
    s_cselect_b32 s101, s62, s101
    buffer_load_dwordx4 v[160:163], v12, s[40:43], s101 offen offset:0 sc1
    s_waitcnt lgkmcnt(10)
    v_mfma_f32_32x32x16_bf16 v[32:47], v[84:87], v[128:131], 0
    ds_read_b64_tr_b16 v[108:109], v9 offset:8192
    ds_read_b64_tr_b16 v[110:111], v9 offset:10240
    s_waitcnt lgkmcnt(10)
    v_mfma_f32_32x32x16_bf16 v[48:63], v[88:91], v[128:131], 0
    ds_read_b64_tr_b16 v[112:113], v10 offset:8192
    ds_read_b64_tr_b16 v[114:115], v10 offset:10240
    buffer_load_dwordx4 v[164:167], v12, s[40:43], s101 offen offset:512 sc1
    s_waitcnt vmcnt(15)
    s_waitcnt lgkmcnt(10)
    v_mfma_f32_32x32x16_bf16 v[16:31], v[92:95], v[132:135], v[16:31]
    ds_read_b64_tr_b16 v[116:117], v8 offset:12288
    ds_read_b64_tr_b16 v[118:119], v8 offset:14336
    s_add_u32 s101, s101, 1024
    s_cmp_eq_u32 s101, s64
    s_waitcnt lgkmcnt(10)
    v_mfma_f32_32x32x16_bf16 v[32:47], v[96:99], v[132:135], v[32:47]
    ds_read_b64_tr_b16 v[120:121], v9 offset:12288
    ds_read_b64_tr_b16 v[122:123], v9 offset:14336
    s_cselect_b32 s101, s62, s101
    buffer_load_dwordx4 v[168:171], v12, s[40:43], s101 offen offset:0 sc1
    s_waitcnt lgkmcnt(10)
    v_mfma_f32_32x32x16_bf16 v[48:63], v[100:103], v[132:135], v[48:63]
    ds_read_b64_tr_b16 v[124:125], v10 offset:12288
    ds_read_b64_tr_b16 v[126:127], v10 offset:14336
    s_waitcnt vmcnt(15)
    s_waitcnt lgkmcnt(10)
    v_mfma_f32_32x32x16_bf16 v[16:31], v[104:107], v[136:139], v[16:31]
    ds_read_b64_tr_b16 v[80:81], v8 offset:16384
    ds_read_b64_tr_b16 v[82:83], v8 offset:18432
    buffer_load_dwordx4 v[172:175], v12, s[40:43], s101 offen offset:512 sc1
    s_waitcnt lgkmcnt(10)
    v_mfma_f32_32x32x16_bf16 v[32:47], v[108:111], v[136:139], v[32:47]
    ds_read_b64_tr_b16 v[84:85], v9 offset:16384
    ds_read_b64_tr_b16 v[86:87], v9 offset:18432
    s_add_u32 s101, s101, 1024
    s_cmp_eq_u32 s101, s64
    s_waitcnt lgkmcnt(10)
    v_mfma_f32_32x32x16_bf16 v[48:63], v[112:115], v[136:139], v[48:63]
    ds_read_b64_tr_b16 v[88:89], v10 offset:16384
    ds_read_b64_tr_b16 v[90:91], v10 offset:18432
    s_cselect_b32 s101, s62, s101
    buffer_load_dwordx4 v[176:179], v12, s[40:43], s101 offen offset:0 sc1
    s_waitcnt vmcnt(16)
    s_waitcnt lgkmcnt(10)
    v_mfma_f32_32x32x16_bf16 v[16:31], v[116:119], v[140:143], v[16:31]
    ds_read_b64_tr_b16 v[92:93], v8 offset:20480
    ds_read_b64_tr_b16 v[94:95], v8 offset:22528
    s_waitcnt lgkmcnt(10)
    v_mfma_f32_32x32x16_bf16 v[32:47], v[120:123], v[140:143], v[32:47]
    ds_read_b64_tr_b16 v[96:97], v9 offset:20480
    ds_read_b64_tr_b16 v[98:99], v9 offset:22528
    buffer_load_dwordx4 v[180:183], v12, s[40:43], s101 offen offset:512 sc1
    s_waitcnt lgkmcnt(10)
    v_mfma_f32_32x32x16_bf16 v[48:63], v[124:127], v[140:143], v[48:63]
    ds_read_b64_tr_b16 v[100:101], v10 offset:20480
    ds_read_b64_tr_b16 v[102:103], v10 offset:22528
    s_add_u32 s101, s101, 1024
    s_cmp_eq_u32 s101, s64
    s_waitcnt vmcnt(16)
    s_waitcnt lgkmcnt(10)
    v_mfma_f32_32x32x16_bf16 v[16:31], v[80:83], v[144:147], v[16:31]
    ds_read_b64_tr_b16 v[104:105], v8 offset:24576
    ds_read_b64_tr_b16 v[106:107], v8 offset:26624
    s_cselect_b32 s101, s62, s101
    buffer_load_dwordx4 v[184:187], v12, s[40:43], s101 offen offset:0 sc1
    s_waitcnt lgkmcnt(10)
    v_mfma_f32_32x32x16_bf16 v[32:47], v[84:87], v[144:147], v[32:47]
    ds_read_b64_tr_b16 v[108:109], v9 offset:24576
    ds_read_b64_tr_b16 v[110:111], v9 offset:26624
    s_waitcnt lgkmcnt(10)
    v_mfma_f32_32x32x16_bf16 v[48:63], v[88:91], v[144:147], v[48:63]
    ds_read_b64_tr_b16 v[112:113], v10 offset:24576
    ds_read_b64_tr_b16 v[114:115], v10 offset:26624
    buffer_load_dwordx4 v[188:191], v12, s[40:43], s101 offen offset:512 sc1
    s_waitcnt vmcnt(17)
    s_waitcnt lgkmcnt(10)
    v_mfma_f32_32x32x16_bf16 v[16:31], v[92:95], v[148:151], v[16:31]
    ds_read_b64_tr_b16 v[116:117], v8 offset:28672
    ds_read_b64_tr_b16 v[118:119], v8 offset:30720
    s_add_u32 s101, s101, 1024
    s_cmp_eq_u32 s101, s64
    s_waitcnt lgkmcnt(10)
    v_mfma_f32_32x32x16_bf16 v[32:47], v[96:99], v[148:151], v[32:47]
    ds_read_b64_tr_b16 v[120:121], v9 offset:28672
    ds_read_b64_tr_b16 v[122:123], v9 offset:30720
    s_cselect_b32 s101, s62, s101
    buffer_load_dwordx4 v[192:195], v12, s[40:43], s101 offen offset:0 sc1
    s_waitcnt lgkmcnt(10)
    v_mfma_f32_32x32x16_bf16 v[48:63], v[100:103], v[148:151], v[48:63]
    ds_read_b64_tr_b16 v[124:125], v10 offset:28672
    ds_read_b64_tr_b16 v[126:127], v10 offset:30720
    s_waitcnt vmcnt(17)
    s_waitcnt lgkmcnt(10)
    v_mfma_f32_32x32x16_bf16 v[16:31], v[104:107], v[152:155], v[16:31]
    ds_read_b64_tr_b16 v[80:81], v8 offset:32768
    ds_read_b64_tr_b16 v[82:83], v8 offset:34816
    buffer_load_dwordx4 v[196:199], v12, s[40:43], s101 offen offset:512 sc1
    s_waitcnt lgkmcnt(10)
    v_mfma_f32_32x32x16_bf16 v[32:47], v[108:111], v[152:155], v[32:47]
    ds_read_b64_tr_b16 v[84:85], v9 offset:32768
    ds_read_b64_tr_b16 v[86:87], v9 offset:34816
    s_add_u32 s101, s101, 1024
    s_cmp_eq_u32 s101, s64
    s_waitcnt lgkmcnt(10)
    v_mfma_f32_32x32x16_bf16 v[48:63], v[112:115], v[152:155], v[48:63]
    ds_read_b64_tr_b16 v[88:89], v10 offset:32768
    ds_read_b64_tr_b16 v[90:91], v10 offset:34816
    s_cselect_b32 s101, s62, s101
    buffer_load_dwordx4 v[200:203], v12, s[40:43], s101 offen offset:0 sc1
    s_waitcnt vmcnt(18)
    s_waitcnt lgkmcnt(10)
    v_mfma_f32_32x32x16_bf16 v[16:31], v[116:119], v[156:159], v[16:31]
    ds_read_b64_tr_b16 v[92:93], v8 offset:36864
    ds_read_b64_tr_b16 v[94:95], v8 offset:38912
    s_waitcnt lgkmcnt(10)
    v_mfma_f32_32x32x16_bf16 v[32:47], v[120:123], v[156:159], v[32:47]
    ds_read_b64_tr_b16 v[96:97], v9 offset:36864
    ds_read_b64_tr_b16 v[98:99], v9 offset:38912
    buffer_load_dwordx4 v[204:207], v12, s[40:43], s101 offen offset:512 sc1
    s_waitcnt lgkmcnt(10)
    v_mfma_f32_32x32x16_bf16 v[48:63], v[124:127], v[156:159], v[48:63]
    ds_read_b64_tr_b16 v[100:101], v10 offset:36864
    ds_read_b64_tr_b16 v[102:103], v10 offset:38912
    s_add_u32 s101, s101, 1024
    s_cmp_eq_u32 s101, s64
    s_waitcnt vmcnt(11)
    s_waitcnt lgkmcnt(10)
    v_mfma_f32_32x32x16_bf16 v[16:31], v[80:83], v[160:163], v[16:31]
    ds_read_b64_tr_b16 v[104:105], v8 offset:40960
    ds_read_b64_tr_b16 v[106:107], v8 offset:43008
    s_cselect_b32 s101, s62, s101
    buffer_load_dwordx4 v[208:211], v12, s[40:43], s101 offen offset:0 sc1
    s_waitcnt lgkmcnt(10)
    v_mfma_f32_32x32x16_bf16 v[32:47], v[84:87], v[160:163], v[32:47]
    ds_read_b64_tr_b16 v[108:109], v9 offset:40960
    ds_read_b64_tr_b16 v[110:111], v9 offset:43008
    s_waitcnt lgkmcnt(10)
    v_mfma_f32_32x32x16_bf16 v[48:63], v[88:91], v[160:163], v[48:63]
    ds_read_b64_tr_b16 v[112:113], v10 offset:40960
    ds_read_b64_tr_b16 v[114:115], v10 offset:43008
    buffer_load_dwordx4 v[212:215], v12, s[40:43], s101 offen offset:512 sc1
    s_waitcnt vmcnt(12)
    s_waitcnt lgkmcnt(10)
    v_mfma_f32_32x32x16_bf16 v[16:31], v[92:95], v[164:167], v[16:31]
    ds_read_b64_tr_b16 v[116:117], v8 offset:45056
    ds_read_b64_tr_b16 v[118:119], v8 offset:47104
    s_add_u32 s101, s101, 1024
    s_cmp_eq_u32 s101, s64
    s_waitcnt lgkmcnt(10)
    v_mfma_f32_32x32x16_bf16 v[32:47], v[96:99], v[164:167], v[32:47]
    ds_read_b64_tr_b16 v[120:121], v9 offset:45056
    ds_read_b64_tr_b16 v[122:123], v9 offset:47104
    s_cselect_b32 s101, s62, s101
    buffer_load_dwordx4 v[216:219], v12, s[40:43], s101 offen offset:0 sc1
    s_waitcnt lgkmcnt(10)
    v_mfma_f32_32x32x16_bf16 v[48:63], v[100:103], v[164:167], v[48:63]
    ds_read_b64_tr_b16 v[124:125], v10 offset:45056
    ds_read_b64_tr_b16 v[126:127], v10 offset:47104
    s_waitcnt vmcnt(12)
    s_waitcnt lgkmcnt(10)
    v_mfma_f32_32x32x16_bf16 v[16:31], v[104:107], v[168:171], v[16:31]
    ds_read_b64_tr_b16 v[80:81], v8 offset:49152
    ds_read_b64_tr_b16 v[82:83], v8 offset:51200
    buffer_load_dwordx4 v[220:223], v12, s[40:43], s101 offen offset:512 sc1
    s_waitcnt lgkmcnt(10)
    v_mfma_f32_32x32x16_bf16 v[32:47], v[108:111], v[168:171], v[32:47]
    ds_read_b64_tr_b16 v[84:85], v9 offset:49152
    ds_read_b64_tr_b16 v[86:87], v9 offset:51200
    s_add_u32 s101, s101, 1024
    s_cmp_eq_u32 s101, s64
    s_waitcnt lgkmcnt(10)
    v_mfma_f32_32x32x16_bf16 v[48:63], v[112:115], v[168:171], v[48:63]
    ds_read_b64_tr_b16 v[88:89], v10 offset:49152
    ds_read_b64_tr_b16 v[90:91], v10 offset:51200
    s_cselect_b32 s101, s62, s101
    buffer_load_dwordx4 v[224:227], v12, s[40:43], s101 offen offset:0 sc1
    s_waitcnt vmcnt(13)
    s_waitcnt lgkmcnt(10)
    v_mfma_f32_32x32x16_bf16 v[16:31], v[116:119], v[172:175], v[16:31]
    ds_read_b64_tr_b16 v[92:93], v8 offset:53248
    ds_read_b64_tr_b16 v[94:95], v8 offset:55296
    s_waitcnt lgkmcnt(10)
    v_mfma_f32_32x32x16_bf16 v[32:47], v[120:123], v[172:175], v[32:47]
    ds_read_b64_tr_b16 v[96:97], v9 offset:53248
    ds_read_b64_tr_b16 v[98:99], v9 offset:55296
    buffer_load_dwordx4 v[228:231], v12, s[40:43], s101 offen offset:512 sc1
    s_waitcnt lgkmcnt(10)
    v_mfma_f32_32x32x16_bf16 v[48:63], v[124:127], v[172:175], v[48:63]
    ds_read_b64_tr_b16 v[100:101], v10 offset:53248
    ds_read_b64_tr_b16 v[102:103], v10 offset:55296
    s_add_u32 s101, s101, 1024
    s_cmp_eq_u32 s101, s64
    s_waitcnt vmcnt(13)
    s_waitcnt lgkmcnt(10)
    v_mfma_f32_32x32x16_bf16 v[16:31], v[80:83], v[176:179], v[16:31]
    ds_read_b64_tr_b16 v[104:105], v248 offset:0
    ds_read_b64_tr_b16 v[106:107], v248 offset:2048
    s_cselect_b32 s101, s62, s101
    buffer_load_dwordx4 v[232:235], v12, s[40:43], s101 offen offset:0 sc1
    s_waitcnt lgkmcnt(10)
    v_mfma_f32_32x32x16_bf16 v[32:47], v[84:87], v[176:179], v[32:47]
    ds_read_b64_tr_b16 v[108:109], v249 offset:0
    ds_read_b64_tr_b16 v[110:111], v249 offset:2048
    s_waitcnt lgkmcnt(10)
    v_mfma_f32_32x32x16_bf16 v[48:63], v[88:91], v[176:179], v[48:63]
    ds_read_b64_tr_b16 v[112:113], v250 offset:0
    ds_read_b64_tr_b16 v[114:115], v250 offset:2048
    buffer_load_dwordx4 v[236:239], v12, s[40:43], s101 offen offset:512 sc1
    s_mov_b64 exec, 1
    ds_add_u32 v2, v3 offset:124
    s_mov_b64 exec, -1
    s_waitcnt vmcnt(14)
    s_waitcnt lgkmcnt(11)
    v_mfma_f32_32x32x16_bf16 v[16:31], v[92:95], v[180:183], v[16:31]
    ds_read_b64_tr_b16 v[116:117], v248 offset:4096
    ds_read_b64_tr_b16 v[118:119], v248 offset:6144
    v_mov_b32 v5, 0
    v_mov_b32 v6, s48
    s_mov_b64 exec, 1
    buffer_store_dword v6, v5, s[40:43], s71 offen sc1
    s_mov_b64 exec, -1
    s_mov_b32 s71, 0x7f000000
    v_add_f32 v66, v66, v68
    v_add_f32 v67, v67, v69
    s_waitcnt lgkmcnt(11)
    v_mfma_f32_32x32x16_bf16 v[32:47], v[96:99], v[180:183], v[32:47]
    ds_read_b64_tr_b16 v[120:121], v249 offset:4096
    ds_read_b64_tr_b16 v[122:123], v249 offset:6144
    s_add_u32 s101, s101, 1024
    s_cmp_eq_u32 s101, s64
    v_add_f32 v70, v70, v72
    v_add_f32 v71, v71, v73
    s_waitcnt lgkmcnt(11)
    v_mfma_f32_32x32x16_bf16 v[48:63], v[100:103], v[180:183], v[48:63]
    ds_read_b64_tr_b16 v[124:125], v250 offset:4096
    ds_read_b64_tr_b16 v[126:127], v250 offset:6144
    s_cselect_b32 s101, s62, s101
    v_add_f32 v74, v74, v76
    v_add_f32 v75, v75, v77
    s_waitcnt vmcnt(14)
    s_waitcnt lgkmcnt(11)
    v_mfma_f32_32x32x16_bf16 v[16:31], v[104:107], v[184:187], v[16:31]
    ds_read_b64_tr_b16 v[80:81], v248 offset:8192
    ds_read_b64_tr_b16 v[82:83], v248 offset:10240
    v_add_f32 v64, v64, v66
    v_add_f32 v70, v70, v74
    s_waitcnt lgkmcnt(11)
    v_mfma_f32_32x32x16_bf16 v[32:47], v[108:111], v[184:187], v[32:47]
    ds_read_b64_tr_b16 v[84:85], v249 offset:8192
    ds_read_b64_tr_b16 v[86:87], v249 offset:10240
    v_add_f32 v65, v65, v67
    v_add_f32 v71, v71, v75
    s_waitcnt lgkmcnt(11)
    v_mfma_f32_32x32x16_bf16 v[48:63], v[112:115], v[184:187], v[48:63]
    ds_read_b64_tr_b16 v[88:89], v250 offset:8192
    ds_read_b64_tr_b16 v[90:91], v250 offset:10240
    v_add_f32 v64, v64, v70
    v_add_f32 v65, v65, v71
    s_waitcnt vmcnt(13)
    s_waitcnt lgkmcnt(10)
    v_mfma_f32_32x32x16_bf16 v[16:31], v[116:119], v[188:191], v[16:31]
    ds_read_b64_tr_b16 v[92:93], v248 offset:12288
    ds_read_b64_tr_b16 v[94:95], v248 offset:14336
    v_mov_b32 v66, v64
    v_mov_b32 v67, v65
    s_waitcnt lgkmcnt(10)
    v_mfma_f32_32x32x16_bf16 v[32:47], v[120:123], v[188:191], v[32:47]
    ds_read_b64_tr_b16 v[96:97], v249 offset:12288
    ds_read_b64_tr_b16 v[98:99], v249 offset:14336
    v_mov_b32 v7, 0
    v_permlane32_swap_b32 v64, v66
    s_waitcnt lgkmcnt(10)
    v_mfma_f32_32x32x16_bf16 v[48:63], v[124:127], v[188:191], v[48:63]
    ds_read_b64_tr_b16 v[100:101], v250 offset:12288
    ds_read_b64_tr_b16 v[102:103], v250 offset:14336
    v_permlane32_swap_b32 v65, v67
    v_add_f32 v64, v64, v66
    s_waitcnt vmcnt(12)
    s_waitcnt lgkmcnt(10)
    v_mfma_f32_32x32x16_bf16 v[16:31], v[80:83], v[192:195], v[16:31]
    ds_read_b64_tr_b16 v[104:105], v248 offset:16384
    ds_read_b64_tr_b16 v[106:107], v248 offset:18432
    v_add_f32 v65, v65, v67
    v_mul_f32 v64, 0xbb124925, v64
    s_waitcnt lgkmcnt(10)
    v_mfma_f32_32x32x16_bf16 v[32:47], v[84:87], v[192:195], v[32:47]
    ds_read_b64_tr_b16 v[108:109], v249 offset:16384
    ds_read_b64_tr_b16 v[110:111], v249 offset:18432
    v_mul_f32 v65, 0x3b124925, v65
    v_fma_f32 v65, -v64, v64, v65
    s_waitcnt lgkmcnt(10)
    v_mfma_f32_32x32x16_bf16 v[48:63], v[88:91], v[192:195], v[48:63]
    ds_read_b64_tr_b16 v[112:113], v250 offset:16384
    ds_read_b64_tr_b16 v[114:115], v250 offset:18432
    v_max_f32 v65, 0, v65
    v_add_f32 v65, 0x3727c5ac, v65
    s_waitcnt vmcnt(11)
    s_waitcnt lgkmcnt(10)
    v_mfma_f32_32x32x16_bf16 v[16:31], v[92:95], v[196:199], v[16:31]
    ds_read_b64_tr_b16 v[116:117], v248 offset:20480
    ds_read_b64_tr_b16 v[118:119], v248 offset:22528
    v_rsq_f32 v252, v65
    s_waitcnt lgkmcnt(10)
    v_mfma_f32_32x32x16_bf16 v[32:47], v[96:99], v[196:199], v[32:47]
    ds_read_b64_tr_b16 v[120:121], v249 offset:20480
    ds_read_b64_tr_b16 v[122:123], v249 offset:22528
    v_cvt_pk_bf16_f32 v66, 0, v64
    v_sub_f32 v67, v64, v66
    s_waitcnt lgkmcnt(10)
    v_mfma_f32_32x32x16_bf16 v[48:63], v[100:103], v[196:199], v[48:63]
    ds_read_b64_tr_b16 v[124:125], v250 offset:20480
    ds_read_b64_tr_b16 v[126:127], v250 offset:22528
    v_mul_f32 v65, v65, v252
    v_mul_f32 v254, 0x3fb8aa3b, v252
    s_waitcnt vmcnt(10)
    s_waitcnt lgkmcnt(10)
    v_mfma_f32_32x32x16_bf16 v[16:31], v[104:107], v[200:203], v[16:31]
    ds_read_b64_tr_b16 v[80:81], v248 offset:24576
    ds_read_b64_tr_b16 v[82:83], v248 offset:26624
    v_mul_f32 v253, -2.0, v252
    v_cvt_pk_bf16_f32 v68, 0, v65
    s_waitcnt lgkmcnt(10)
    v_mfma_f32_32x32x16_bf16 v[32:47], v[108:111], v[200:203], v[32:47]
    ds_read_b64_tr_b16 v[84:85], v249 offset:24576
    ds_read_b64_tr_b16 v[86:87], v249 offset:26624
    v_sub_f32 v69, v65, v68
    v_cvt_pk_bf16_f32 v4, v66, v67
    s_waitcnt lgkmcnt(10)
    v_mfma_f32_32x32x16_bf16 v[48:63], v[112:115], v[200:203], v[48:63]
    ds_read_b64_tr_b16 v[88:89], v250 offset:24576
    ds_read_b64_tr_b16 v[90:91], v250 offset:26624
    v_cvt_pk_bf16_f32 v5, v66, v68
    v_cvt_pk_bf16_f32 v6, v69, 0
    s_waitcnt vmcnt(9)
    s_waitcnt lgkmcnt(10)
    v_mfma_f32_32x32x16_bf16 v[16:31], v[116:119], v[204:207], v[16:31]
    ds_read_b64_tr_b16 v[92:93], v248 offset:28672
    ds_read_b64_tr_b16 v[94:95], v248 offset:30720
    s_waitcnt lgkmcnt(10)
    v_mfma_f32_32x32x16_bf16 v[32:47], v[120:123], v[204:207], v[32:47]
    ds_read_b64_tr_b16 v[96:97], v249 offset:28672
    ds_read_b64_tr_b16 v[98:99], v249 offset:30720
    s_waitcnt lgkmcnt(10)
    v_mfma_f32_32x32x16_bf16 v[48:63], v[124:127], v[204:207], v[48:63]
    ds_read_b64_tr_b16 v[100:101], v250 offset:28672
    ds_read_b64_tr_b16 v[102:103], v250 offset:30720
    s_waitcnt vmcnt(8)
    s_waitcnt lgkmcnt(10)
    v_mfma_f32_32x32x16_bf16 v[16:31], v[80:83], v[208:211], v[16:31]
    ds_read_b64_tr_b16 v[104:105], v248 offset:32768
    ds_read_b64_tr_b16 v[106:107], v248 offset:34816
    s_waitcnt lgkmcnt(10)
    v_mfma_f32_32x32x16_bf16 v[32:47], v[84:87], v[208:211], v[32:47]
    ds_read_b64_tr_b16 v[108:109], v249 offset:32768
    ds_read_b64_tr_b16 v[110:111], v249 offset:34816
    s_waitcnt lgkmcnt(10)
    v_mfma_f32_32x32x16_bf16 v[48:63], v[88:91], v[208:211], v[48:63]
    ds_read_b64_tr_b16 v[112:113], v250 offset:32768
    ds_read_b64_tr_b16 v[114:115], v250 offset:34816
    s_waitcnt vmcnt(7)
    s_waitcnt lgkmcnt(10)
    v_mfma_f32_32x32x16_bf16 v[16:31], v[92:95], v[212:215], v[16:31]
    ds_read_b64_tr_b16 v[116:117], v248 offset:36864
    ds_read_b64_tr_b16 v[118:119], v248 offset:38912
    s_waitcnt lgkmcnt(10)
    v_mfma_f32_32x32x16_bf16 v[32:47], v[96:99], v[212:215], v[32:47]
    ds_read_b64_tr_b16 v[120:121], v249 offset:36864
    ds_read_b64_tr_b16 v[122:123], v249 offset:38912
    s_waitcnt lgkmcnt(10)
    v_mfma_f32_32x32x16_bf16 v[48:63], v[100:103], v[212:215], v[48:63]
    ds_read_b64_tr_b16 v[124:125], v250 offset:36864
    ds_read_b64_tr_b16 v[126:127], v250 offset:38912
    s_waitcnt vmcnt(6)
    s_waitcnt lgkmcnt(10)
    v_mfma_f32_32x32x16_bf16 v[16:31], v[104:107], v[216:219], v[16:31]
    ds_read_b64_tr_b16 v[80:81], v248 offset:40960
    ds_read_b64_tr_b16 v[82:83], v248 offset:43008
    s_waitcnt lgkmcnt(10)
    v_mfma_f32_32x32x16_bf16 v[32:47], v[108:111], v[216:219], v[32:47]
    ds_read_b64_tr_b16 v[84:85], v249 offset:40960
    ds_read_b64_tr_b16 v[86:87], v249 offset:43008
    s_waitcnt lgkmcnt(10)
    v_mfma_f32_32x32x16_bf16 v[48:63], v[112:115], v[216:219], v[48:63]
    ds_read_b64_tr_b16 v[88:89], v250 offset:40960
    ds_read_b64_tr_b16 v[90:91], v250 offset:43008
    s_waitcnt vmcnt(5)
    s_waitcnt lgkmcnt(10)
    v_mfma_f32_32x32x16_bf16 v[16:31], v[116:119], v[220:223], v[16:31]
    ds_read_b64_tr_b16 v[92:93], v248 offset:45056
    ds_read_b64_tr_b16 v[94:95], v248 offset:47104
    s_waitcnt lgkmcnt(10)
    v_mfma_f32_32x32x16_bf16 v[32:47], v[120:123], v[220:223], v[32:47]
    ds_read_b64_tr_b16 v[96:97], v249 offset:45056
    ds_read_b64_tr_b16 v[98:99], v249 offset:47104
    s_waitcnt lgkmcnt(10)
    v_mfma_f32_32x32x16_bf16 v[48:63], v[124:127], v[220:223], v[48:63]
    ds_read_b64_tr_b16 v[100:101], v250 offset:45056
    ds_read_b64_tr_b16 v[102:103], v250 offset:47104
    s_waitcnt vmcnt(4)
    s_waitcnt lgkmcnt(10)
    v_mfma_f32_32x32x16_bf16 v[16:31], v[80:83], v[224:227], v[16:31]
    ds_read_b64_tr_b16 v[104:105], v248 offset:49152
    ds_read_b64_tr_b16 v[106:107], v248 offset:51200
    s_waitcnt lgkmcnt(10)
    v_mfma_f32_32x32x16_bf16 v[32:47], v[84:87], v[224:227], v[32:47]
    ds_read_b64_tr_b16 v[108:109], v249 offset:49152
    ds_read_b64_tr_b16 v[110:111], v249 offset:51200
    s_waitcnt lgkmcnt(10)
    v_mfma_f32_32x32x16_bf16 v[48:63], v[88:91], v[224:227], v[48:63]
    ds_read_b64_tr_b16 v[112:113], v250 offset:49152
    ds_read_b64_tr_b16 v[114:115], v250 offset:51200
    s_waitcnt vmcnt(3)
    s_waitcnt lgkmcnt(10)
    v_mfma_f32_32x32x16_bf16 v[16:31], v[92:95], v[228:231], v[16:31]
    ds_read_b64_tr_b16 v[116:117], v248 offset:53248
    ds_read_b64_tr_b16 v[118:119], v248 offset:55296
    s_waitcnt lgkmcnt(10)
    v_mfma_f32_32x32x16_bf16 v[32:47], v[96:99], v[228:231], v[32:47]
    ds_read_b64_tr_b16 v[120:121], v249 offset:53248
    ds_read_b64_tr_b16 v[122:123], v249 offset:55296
    s_waitcnt lgkmcnt(10)
    v_mfma_f32_32x32x16_bf16 v[48:63], v[100:103], v[228:231], v[48:63]
    ds_read_b64_tr_b16 v[124:125], v250 offset:53248
    ds_read_b64_tr_b16 v[126:127], v250 offset:55296
    s_waitcnt vmcnt(2)
    s_waitcnt lgkmcnt(10)
    v_mfma_f32_32x32x16_bf16 v[16:31], v[104:107], v[232:235], v[16:31]
    ds_read_b128 v[80:83], v15 offset:0
    s_waitcnt lgkmcnt(9)
    v_mfma_f32_32x32x16_bf16 v[32:47], v[108:111], v[232:235], v[32:47]
    ds_read_b128 v[84:87], v15 offset:1024
    s_waitcnt lgkmcnt(8)
    v_mfma_f32_32x32x16_bf16 v[48:63], v[112:115], v[232:235], v[48:63]
    ds_read_b128 v[88:91], v15 offset:2048
    s_waitcnt vmcnt(1)
    s_waitcnt lgkmcnt(7)
    v_mfma_f32_32x32x16_bf16 v[16:31], v[116:119], v[236:239], v[16:31]
    ds_read_b64_tr_b16 v[92:93], v11 offset:0
    ds_read_b64_tr_b16 v[94:95], v11 offset:2048
    s_waitcnt lgkmcnt(7)
    v_mfma_f32_32x32x16_bf16 v[32:47], v[120:123], v[236:239], v[32:47]
    ds_read_b64_tr_b16 v[96:97], v11 offset:4096
    ds_read_b64_tr_b16 v[98:99], v11 offset:6144
    s_waitcnt lgkmcnt(7)
    v_mfma_f32_32x32x16_bf16 v[48:63], v[124:127], v[236:239], v[48:63]
    ds_read_b64_tr_b16 v[100:101], v11 offset:8192
    ds_read_b64_tr_b16 v[102:103], v11 offset:10240
    s_waitcnt lgkmcnt(8)
    v_mfma_f32_32x32x16_bf16 v[16:31], v[80:83], v[4:7], v[16:31]
    ds_read_b64_tr_b16 v[104:105], v11 offset:12288
    ds_read_b64_tr_b16 v[106:107], v11 offset:14336
    s_waitcnt lgkmcnt(9)
    v_mfma_f32_32x32x16_bf16 v[32:47], v[84:87], v[4:7], v[32:47]
    ds_read_b64_tr_b16 v[108:109], v11 offset:16384
    ds_read_b64_tr_b16 v[110:111], v11 offset:18432
    s_waitcnt lgkmcnt(10)
    v_mfma_f32_32x32x16_bf16 v[48:63], v[88:91], v[4:7], v[48:63]
    ds_read_b64_tr_b16 v[112:113], v11 offset:20480
    ds_read_b64_tr_b16 v[114:115], v11 offset:22528
    s_waitcnt lgkmcnt(10)
    v_mfma_f32_32x32x16_bf16 v[64:79], v[92:95], v[128:131], 0
    ds_read_b64_tr_b16 v[116:117], v11 offset:24576
    ds_read_b64_tr_b16 v[118:119], v11 offset:26624
    s_waitcnt lgkmcnt(10)
    v_mfma_f32_32x32x16_bf16 v[64:79], v[96:99], v[132:135], v[64:79]
    ds_read_b64_tr_b16 v[120:121], v11 offset:28672
    ds_read_b64_tr_b16 v[122:123], v11 offset:30720
    s_waitcnt lgkmcnt(10)
    v_mfma_f32_32x32x16_bf16 v[64:79], v[100:103], v[136:139], v[64:79]
    ds_read_b64_tr_b16 v[124:125], v11 offset:32768
    ds_read_b64_tr_b16 v[126:127], v11 offset:34816
    s_waitcnt lgkmcnt(10)
    v_mfma_f32_32x32x16_bf16 v[64:79], v[104:107], v[140:143], v[64:79]
    ds_read_b64_tr_b16 v[80:81], v11 offset:36864
    ds_read_b64_tr_b16 v[82:83], v11 offset:38912
    s_waitcnt lgkmcnt(10)
    v_mfma_f32_32x32x16_bf16 v[64:79], v[108:111], v[144:147], v[64:79]
    ds_read_b64_tr_b16 v[84:85], v11 offset:40960
    ds_read_b64_tr_b16 v[86:87], v11 offset:43008
    v_mul_f32 v128, v16, v254
    v_mul_f32 v129, v17, v254
    v_mul_f32 v130, v18, v254
    v_mul_f32 v131, v19, v254
    s_waitcnt lgkmcnt(10)
    v_mfma_f32_32x32x16_bf16 v[64:79], v[112:115], v[148:151], v[64:79]
    ds_read_b64_tr_b16 v[88:89], v11 offset:45056
    ds_read_b64_tr_b16 v[90:91], v11 offset:47104
    v_mul_f32 v132, v20, v254
    v_mul_f32 v133, v21, v254
    v_mul_f32 v134, v22, v254
    v_mul_f32 v135, v23, v254
    s_waitcnt lgkmcnt(10)
    v_mfma_f32_32x32x16_bf16 v[64:79], v[116:119], v[152:155], v[64:79]
    ds_read_b64_tr_b16 v[92:93], v11 offset:49152
    ds_read_b64_tr_b16 v[94:95], v11 offset:51200
    v_exp_f32 v128, v128
    v_exp_f32 v129, v129
    s_waitcnt lgkmcnt(10)
    v_mfma_f32_32x32x16_bf16 v[64:79], v[120:123], v[156:159], v[64:79]
    ds_read_b64_tr_b16 v[96:97], v11 offset:53248
    ds_read_b64_tr_b16 v[98:99], v11 offset:55296
    v_exp_f32 v130, v130
    v_exp_f32 v131, v131
    s_waitcnt lgkmcnt(10)
    v_mfma_f32_32x32x16_bf16 v[64:79], v[124:127], v[160:163], v[64:79]
    ds_read_b64_tr_b16 v[100:101], v251 offset:0
    ds_read_b64_tr_b16 v[102:103], v251 offset:2048
    v_exp_f32 v132, v132
    v_exp_f32 v133, v133
    s_waitcnt lgkmcnt(10)
    v_mfma_f32_32x32x16_bf16 v[64:79], v[80:83], v[164:167], v[64:79]
    ds_read_b64_tr_b16 v[104:105], v251 offset:4096
    ds_read_b64_tr_b16 v[106:107], v251 offset:6144
    v_exp_f32 v134, v134
    v_exp_f32 v135, v135
    s_waitcnt lgkmcnt(10)
    v_mfma_f32_32x32x16_bf16 v[64:79], v[84:87], v[168:171], v[64:79]
    ds_read_b64_tr_b16 v[108:109], v251 offset:8192
    ds_read_b64_tr_b16 v[110:111], v251 offset:10240
    v_add_f32 v128, 1.0, v128
    v_add_f32 v129, 1.0, v129
    v_add_f32 v130, 1.0, v130
    v_add_f32 v131, 1.0, v131
    s_waitcnt lgkmcnt(10)
    v_mfma_f32_32x32x16_bf16 v[64:79], v[88:91], v[172:175], v[64:79]
    ds_read_b64_tr_b16 v[112:113], v251 offset:12288
    ds_read_b64_tr_b16 v[114:115], v251 offset:14336
    v_add_f32 v132, 1.0, v132
    v_add_f32 v133, 1.0, v133
    v_add_f32 v134, 1.0, v134
    v_add_f32 v135, 1.0, v135
    s_waitcnt lgkmcnt(10)
    v_mfma_f32_32x32x16_bf16 v[64:79], v[92:95], v[176:179], v[64:79]
    ds_read_b64_tr_b16 v[116:117], v251 offset:16384
    ds_read_b64_tr_b16 v[118:119], v251 offset:18432
    v_fma_f32 v128, v128, v128, 1.0
    v_fma_f32 v129, v129, v129, 1.0
    v_fma_f32 v130, v130, v130, 1.0
    v_fma_f32 v131, v131, v131, 1.0
    s_waitcnt lgkmcnt(10)
    v_mfma_f32_32x32x16_bf16 v[64:79], v[96:99], v[180:183], v[64:79]
    ds_read_b64_tr_b16 v[120:121], v251 offset:20480
    ds_read_b64_tr_b16 v[122:123], v251 offset:22528
    v_fma_f32 v132, v132, v132, 1.0
    v_fma_f32 v133, v133, v133, 1.0
    v_fma_f32 v134, v134, v134, 1.0
    v_fma_f32 v135, v135, v135, 1.0
    s_waitcnt lgkmcnt(10)
    v_mfma_f32_32x32x16_bf16 v[64:79], v[100:103], v[184:187], v[64:79]
    ds_read_b64_tr_b16 v[124:125], v251 offset:24576
    ds_read_b64_tr_b16 v[126:127], v251 offset:26624
    v_rcp_f32 v128, v128
    v_rcp_f32 v129, v129
    s_waitcnt lgkmcnt(10)
    v_mfma_f32_32x32x16_bf16 v[64:79], v[104:107], v[188:191], v[64:79]
    ds_read_b64_tr_b16 v[80:81], v251 offset:28672
    ds_read_b64_tr_b16 v[82:83], v251 offset:30720
    v_rcp_f32 v130, v130
    v_rcp_f32 v131, v131
    s_waitcnt lgkmcnt(10)
    v_mfma_f32_32x32x16_bf16 v[64:79], v[108:111], v[192:195], v[64:79]
    ds_read_b64_tr_b16 v[84:85], v251 offset:32768
    ds_read_b64_tr_b16 v[86:87], v251 offset:34816
    v_rcp_f32 v132, v132
    v_rcp_f32 v133, v133
    s_waitcnt lgkmcnt(10)
    v_mfma_f32_32x32x16_bf16 v[64:79], v[112:115], v[196:199], v[64:79]
    ds_read_b64_tr_b16 v[88:89], v251 offset:36864
    ds_read_b64_tr_b16 v[90:91], v251 offset:38912
    v_rcp_f32 v134, v134
    v_rcp_f32 v135, v135
    s_waitcnt lgkmcnt(10)
    v_mfma_f32_32x32x16_bf16 v[64:79], v[116:119], v[200:203], v[64:79]
    ds_read_b64_tr_b16 v[92:93], v251 offset:40960
    ds_read_b64_tr_b16 v[94:95], v251 offset:43008
    v_fma_f32 v128, v128, v253, v252
    v_fma_f32 v129, v129, v253, v252
    v_fma_f32 v130, v130, v253, v252
    v_fma_f32 v131, v131, v253, v252
    s_waitcnt lgkmcnt(10)
    v_mfma_f32_32x32x16_bf16 v[64:79], v[120:123], v[204:207], v[64:79]
    ds_read_b64_tr_b16 v[96:97], v251 offset:45056
    ds_read_b64_tr_b16 v[98:99], v251 offset:47104
    v_fma_f32 v132, v132, v253, v252
    v_fma_f32 v133, v133, v253, v252
    v_fma_f32 v134, v134, v253, v252
    v_fma_f32 v135, v135, v253, v252
    s_waitcnt lgkmcnt(10)
    v_mfma_f32_32x32x16_bf16 v[64:79], v[124:127], v[208:211], v[64:79]
    ds_read_b64_tr_b16 v[100:101], v251 offset:49152
    ds_read_b64_tr_b16 v[102:103], v251 offset:51200
    v_mul_f32 v128, v128, v16
    v_mul_f32 v129, v129, v17
    v_mul_f32 v130, v130, v18
    v_mul_f32 v131, v131, v19
    s_waitcnt lgkmcnt(10)
    v_mfma_f32_32x32x16_bf16 v[64:79], v[80:83], v[212:215], v[64:79]
    ds_read_b64_tr_b16 v[104:105], v251 offset:53248
    ds_read_b64_tr_b16 v[106:107], v251 offset:55296
    v_mul_f32 v132, v132, v20
    v_mul_f32 v133, v133, v21
    v_mul_f32 v134, v134, v22
    v_mul_f32 v135, v135, v23
    s_waitcnt lgkmcnt(10)
    v_mfma_f32_32x32x16_bf16 v[64:79], v[84:87], v[216:219], v[64:79]
    ds_read_b128 v[108:111], v15 offset:3072
    v_cvt_pk_bf16_f32 v16, v128, v129
    v_cvt_pk_bf16_f32 v17, v130, v131
    v_cvt_pk_bf16_f32 v18, v132, v133
    v_cvt_pk_bf16_f32 v19, v134, v135
    s_waitcnt lgkmcnt(9)
    v_mfma_f32_32x32x16_bf16 v[64:79], v[88:91], v[220:223], v[64:79]
    buffer_store_dwordx4 v[16:19], v13, s[40:43], s77 offen offset:0 sc1
    v_mul_f32 v136, v24, v254
    v_mul_f32 v137, v25, v254
    v_mul_f32 v138, v26, v254
    s_waitcnt lgkmcnt(7)
    v_mfma_f32_32x32x16_bf16 v[64:79], v[92:95], v[224:227], v[64:79]
    v_mul_f32 v139, v27, v254
    v_mul_f32 v140, v28, v254
    v_mul_f32 v141, v29, v254
    v_mul_f32 v142, v30, v254
    s_waitcnt lgkmcnt(5)
    v_mfma_f32_32x32x16_bf16 v[64:79], v[96:99], v[228:231], v[64:79]
    v_mul_f32 v143, v31, v254
    v_exp_f32 v136, v136
    s_waitcnt lgkmcnt(3)
    v_mfma_f32_32x32x16_bf16 v[64:79], v[100:103], v[232:235], v[64:79]
    v_exp_f32 v137, v137
    v_exp_f32 v138, v138
    s_waitcnt lgkmcnt(1)
    v_mfma_f32_32x32x16_bf16 v[64:79], v[104:107], v[236:239], v[64:79]
    v_exp_f32 v139, v139
    v_exp_f32 v140, v140
    s_waitcnt lgkmcnt(0)
    v_mfma_f32_32x32x16_bf16 v[64:79], v[108:111], v[4:7], v[64:79]
    v_exp_f32 v141, v141
    v_exp_f32 v142, v142
    s_mov_b64 exec, 1
    ds_add_u32 v2, v3 offset:36
    s_mov_b64 exec, -1
    v_exp_f32 v143, v143
    v_add_f32 v136, 1.0, v136
    v_add_f32 v137, 1.0, v137
    v_add_f32 v138, 1.0, v138
    v_add_f32 v139, 1.0, v139
    v_add_f32 v140, 1.0, v140
    v_add_f32 v141, 1.0, v141
    v_add_f32 v142, 1.0, v142
    v_add_f32 v143, 1.0, v143
    v_fma_f32 v136, v136, v136, 1.0
    v_fma_f32 v137, v137, v137, 1.0
    v_fma_f32 v138, v138, v138, 1.0
    v_fma_f32 v139, v139, v139, 1.0
    v_fma_f32 v140, v140, v140, 1.0
    v_fma_f32 v141, v141, v141, 1.0
    v_fma_f32 v142, v142, v142, 1.0
    v_fma_f32 v143, v143, v143, 1.0
    v_rcp_f32 v136, v136
    v_rcp_f32 v137, v137
    v_rcp_f32 v138, v138
    v_rcp_f32 v139, v139
    v_rcp_f32 v140, v140
    v_rcp_f32 v141, v141
    v_rcp_f32 v142, v142
    v_rcp_f32 v143, v143
    v_fma_f32 v136, v136, v253, v252
    v_fma_f32 v137, v137, v253, v252
    v_fma_f32 v138, v138, v253, v252
    v_fma_f32 v139, v139, v253, v252
    v_fma_f32 v140, v140, v253, v252
    v_fma_f32 v141, v141, v253, v252
    v_fma_f32 v142, v142, v253, v252
    v_fma_f32 v143, v143, v253, v252
    v_mul_f32 v136, v136, v24
    v_mul_f32 v137, v137, v25
    v_mul_f32 v138, v138, v26
    v_mul_f32 v139, v139, v27
    v_mul_f32 v140, v140, v28
    v_mul_f32 v141, v141, v29
    v_mul_f32 v142, v142, v30
    v_mul_f32 v143, v143, v31
    v_cvt_pk_bf16_f32 v24, v136, v137
    v_cvt_pk_bf16_f32 v25, v138, v139
    v_cvt_pk_bf16_f32 v26, v140, v141
    v_cvt_pk_bf16_f32 v27, v142, v143
    buffer_store_dwordx4 v[24:27], v13, s[40:43], s77 offen offset:512 sc1
    v_pk_mul_f32 v[128:129], v[32:33], v[254:255] op_sel_hi:[1,0]
    v_pk_mul_f32 v[130:131], v[34:35], v[254:255] op_sel_hi:[1,0]
    v_pk_mul_f32 v[132:133], v[36:37], v[254:255] op_sel_hi:[1,0]
    v_pk_mul_f32 v[134:135], v[38:39], v[254:255] op_sel_hi:[1,0]
    v_exp_f32 v128, v128
    v_exp_f32 v129, v129
    v_exp_f32 v130, v130
    v_exp_f32 v131, v131
    v_exp_f32 v132, v132
    v_exp_f32 v133, v133
    v_exp_f32 v134, v134
    v_exp_f32 v135, v135
    v_pk_add_f32 v[128:129], v[128:129], 1.0 op_sel_hi:[1,0]
    v_pk_add_f32 v[130:131], v[130:131], 1.0 op_sel_hi:[1,0]
    v_pk_add_f32 v[132:133], v[132:133], 1.0 op_sel_hi:[1,0]
    v_pk_add_f32 v[134:135], v[134:135], 1.0 op_sel_hi:[1,0]
    v_pk_fma_f32 v[128:129], v[128:129], v[128:129], 1.0 op_sel_hi:[1,1,0]
    v_pk_fma_f32 v[130:131], v[130:131], v[130:131], 1.0 op_sel_hi:[1,1,0]
    v_pk_fma_f32 v[132:133], v[132:133], v[132:133], 1.0 op_sel_hi:[1,1,0]
    v_pk_fma_f32 v[134:135], v[134:135], v[134:135], 1.0 op_sel_hi:[1,1,0]
    v_rcp_f32 v128, v128
    v_rcp_f32 v129, v129
    v_rcp_f32 v130, v130
    v_rcp_f32 v131, v131
    v_rcp_f32 v132, v132
    v_rcp_f32 v133, v133
    v_rcp_f32 v134, v134
    v_rcp_f32 v135, v135
    v_pk_fma_f32 v[128:129], v[128:129], v[252:253], v[252:253] op_sel:[0,1,0] op_sel_hi:[1,1,0]
    v_pk_fma_f32 v[130:131], v[130:131], v[252:253], v[252:253] op_sel:[0,1,0] op_sel_hi:[1,1,0]
    v_pk_fma_f32 v[132:133], v[132:133], v[252:253], v[252:253] op_sel:[0,1,0] op_sel_hi:[1,1,0]
    v_pk_fma_f32 v[134:135], v[134:135], v[252:253], v[252:253] op_sel:[0,1,0] op_sel_hi:[1,1,0]
    v_pk_mul_f32 v[128:129], v[128:129], v[32:33]
    v_pk_mul_f32 v[130:131], v[130:131], v[34:35]
    v_pk_mul_f32 v[132:133], v[132:133], v[36:37]
    v_pk_mul_f32 v[134:135], v[134:135], v[38:39]
    v_cvt_pk_bf16_f32 v32, v128, v129
    v_cvt_pk_bf16_f32 v33, v130, v131
    v_cvt_pk_bf16_f32 v34, v132, v133
    v_cvt_pk_bf16_f32 v35, v134, v135
    buffer_store_dwordx4 v[32:35], v13, s[40:43], s77 offen offset:1024 sc1
    v_pk_mul_f32 v[136:137], v[40:41], v[254:255] op_sel_hi:[1,0]
    v_pk_mul_f32 v[138:139], v[42:43], v[254:255] op_sel_hi:[1,0]
    v_pk_mul_f32 v[140:141], v[44:45], v[254:255] op_sel_hi:[1,0]
    v_pk_mul_f32 v[142:143], v[46:47], v[254:255] op_sel_hi:[1,0]
    v_exp_f32 v136, v136
    v_exp_f32 v137, v137
    v_exp_f32 v138, v138
    v_exp_f32 v139, v139
    v_exp_f32 v140, v140
    v_exp_f32 v141, v141
    v_exp_f32 v142, v142
    v_exp_f32 v143, v143
    v_pk_add_f32 v[136:137], v[136:137], 1.0 op_sel_hi:[1,0]
    v_pk_add_f32 v[138:139], v[138:139], 1.0 op_sel_hi:[1,0]
    v_pk_add_f32 v[140:141], v[140:141], 1.0 op_sel_hi:[1,0]
    v_pk_add_f32 v[142:143], v[142:143], 1.0 op_sel_hi:[1,0]
    v_pk_fma_f32 v[136:137], v[136:137], v[136:137], 1.0 op_sel_hi:[1,1,0]
    v_pk_fma_f32 v[138:139], v[138:139], v[138:139], 1.0 op_sel_hi:[1,1,0]
    v_pk_fma_f32 v[140:141], v[140:141], v[140:141], 1.0 op_sel_hi:[1,1,0]
    v_pk_fma_f32 v[142:143], v[142:143], v[142:143], 1.0 op_sel_hi:[1,1,0]
    v_rcp_f32 v136, v136
    v_rcp_f32 v137, v137
    v_rcp_f32 v138, v138
    v_rcp_f32 v139, v139
    v_rcp_f32 v140, v140
    v_rcp_f32 v141, v141
    v_rcp_f32 v142, v142
    v_rcp_f32 v143, v143
    v_pk_fma_f32 v[136:137], v[136:137], v[252:253], v[252:253] op_sel:[0,1,0] op_sel_hi:[1,1,0]
    v_pk_fma_f32 v[138:139], v[138:139], v[252:253], v[252:253] op_sel:[0,1,0] op_sel_hi:[1,1,0]
    v_pk_fma_f32 v[140:141], v[140:141], v[252:253], v[252:253] op_sel:[0,1,0] op_sel_hi:[1,1,0]
    v_pk_fma_f32 v[142:143], v[142:143], v[252:253], v[252:253] op_sel:[0,1,0] op_sel_hi:[1,1,0]
    v_pk_mul_f32 v[136:137], v[136:137], v[40:41]
    v_pk_mul_f32 v[138:139], v[138:139], v[42:43]
    v_pk_mul_f32 v[140:141], v[140:141], v[44:45]
    v_pk_mul_f32 v[142:143], v[142:143], v[46:47]
    v_cvt_pk_bf16_f32 v40, v136, v137
    v_cvt_pk_bf16_f32 v41, v138, v139
    v_cvt_pk_bf16_f32 v42, v140, v141
    v_cvt_pk_bf16_f32 v43, v142, v143
    buffer_store_dwordx4 v[40:43], v13, s[40:43], s77 offen offset:1536 sc1
    v_pk_mul_f32 v[128:129], v[48:49], v[254:255] op_sel_hi:[1,0]
    v_pk_mul_f32 v[130:131], v[50:51], v[254:255] op_sel_hi:[1,0]
    v_pk_mul_f32 v[132:133], v[52:53], v[254:255] op_sel_hi:[1,0]
    v_pk_mul_f32 v[134:135], v[54:55], v[254:255] op_sel_hi:[1,0]
    v_exp_f32 v128, v128
    v_exp_f32 v129, v129
    v_exp_f32 v130, v130
    v_exp_f32 v131, v131
    v_exp_f32 v132, v132
    v_exp_f32 v133, v133
    v_exp_f32 v134, v134
    v_exp_f32 v135, v135
    v_pk_add_f32 v[128:129], v[128:129], 1.0 op_sel_hi:[1,0]
    v_pk_add_f32 v[130:131], v[130:131], 1.0 op_sel_hi:[1,0]
    v_pk_add_f32 v[132:133], v[132:133], 1.0 op_sel_hi:[1,0]
    v_pk_add_f32 v[134:135], v[134:135], 1.0 op_sel_hi:[1,0]
    v_pk_fma_f32 v[128:129], v[128:129], v[128:129], 1.0 op_sel_hi:[1,1,0]
    v_pk_fma_f32 v[130:131], v[130:131], v[130:131], 1.0 op_sel_hi:[1,1,0]
    v_pk_fma_f32 v[132:133], v[132:133], v[132:133], 1.0 op_sel_hi:[1,1,0]
    v_pk_fma_f32 v[134:135], v[134:135], v[134:135], 1.0 op_sel_hi:[1,1,0]
    v_rcp_f32 v128, v128
    v_rcp_f32 v129, v129
    v_rcp_f32 v130, v130
    v_rcp_f32 v131, v131
    v_rcp_f32 v132, v132
    v_rcp_f32 v133, v133
    v_rcp_f32 v134, v134
    v_rcp_f32 v135, v135
    v_pk_fma_f32 v[128:129], v[128:129], v[252:253], v[252:253] op_sel:[0,1,0] op_sel_hi:[1,1,0]
    v_pk_fma_f32 v[130:131], v[130:131], v[252:253], v[252:253] op_sel:[0,1,0] op_sel_hi:[1,1,0]
    v_pk_fma_f32 v[132:133], v[132:133], v[252:253], v[252:253] op_sel:[0,1,0] op_sel_hi:[1,1,0]
    v_pk_fma_f32 v[134:135], v[134:135], v[252:253], v[252:253] op_sel:[0,1,0] op_sel_hi:[1,1,0]
    v_pk_mul_f32 v[128:129], v[128:129], v[48:49]
    v_pk_mul_f32 v[130:131], v[130:131], v[50:51]
    v_pk_mul_f32 v[132:133], v[132:133], v[52:53]
    v_pk_mul_f32 v[134:135], v[134:135], v[54:55]
    v_cvt_pk_bf16_f32 v48, v128, v129
    v_cvt_pk_bf16_f32 v49, v130, v131
    v_cvt_pk_bf16_f32 v50, v132, v133
    v_cvt_pk_bf16_f32 v51, v134, v135
    buffer_store_dwordx4 v[48:51], v13, s[40:43], s77 offen offset:2048 sc1
    v_pk_mul_f32 v[136:137], v[56:57], v[254:255] op_sel_hi:[1,0]
    v_pk_mul_f32 v[138:139], v[58:59], v[254:255] op_sel_hi:[1,0]
    v_pk_mul_f32 v[140:141], v[60:61], v[254:255] op_sel_hi:[1,0]
    v_pk_mul_f32 v[142:143], v[62:63], v[254:255] op_sel_hi:[1,0]
    v_exp_f32 v136, v136
    v_exp_f32 v137, v137
    v_exp_f32 v138, v138
    v_exp_f32 v139, v139
    v_exp_f32 v140, v140
    v_exp_f32 v141, v141
    v_exp_f32 v142, v142
    v_exp_f32 v143, v143
    v_pk_add_f32 v[136:137], v[136:137], 1.0 op_sel_hi:[1,0]
    v_pk_add_f32 v[138:139], v[138:139], 1.0 op_sel_hi:[1,0]
    v_pk_add_f32 v[140:141], v[140:141], 1.0 op_sel_hi:[1,0]
    v_pk_add_f32 v[142:143], v[142:143], 1.0 op_sel_hi:[1,0]
    v_pk_fma_f32 v[136:137], v[136:137], v[136:137], 1.0 op_sel_hi:[1,1,0]
    v_pk_fma_f32 v[138:139], v[138:139], v[138:139], 1.0 op_sel_hi:[1,1,0]
    v_pk_fma_f32 v[140:141], v[140:141], v[140:141], 1.0 op_sel_hi:[1,1,0]
    v_pk_fma_f32 v[142:143], v[142:143], v[142:143], 1.0 op_sel_hi:[1,1,0]
    v_rcp_f32 v136, v136
    v_rcp_f32 v137, v137
    v_rcp_f32 v138, v138
    v_rcp_f32 v139, v139
    v_rcp_f32 v140, v140
    v_rcp_f32 v141, v141
    v_rcp_f32 v142, v142
    v_rcp_f32 v143, v143
    v_pk_fma_f32 v[136:137], v[136:137], v[252:253], v[252:253] op_sel:[0,1,0] op_sel_hi:[1,1,0]
    v_pk_fma_f32 v[138:139], v[138:139], v[252:253], v[252:253] op_sel:[0,1,0] op_sel_hi:[1,1,0]
    v_pk_fma_f32 v[140:141], v[140:141], v[252:253], v[252:253] op_sel:[0,1,0] op_sel_hi:[1,1,0]
    v_pk_fma_f32 v[142:143], v[142:143], v[252:253], v[252:253] op_sel:[0,1,0] op_sel_hi:[1,1,0]
    v_pk_mul_f32 v[136:137], v[136:137], v[56:57]
    v_pk_mul_f32 v[138:139], v[138:139], v[58:59]
    v_pk_mul_f32 v[140:141], v[140:141], v[60:61]
    v_pk_mul_f32 v[142:143], v[142:143], v[62:63]
    v_cvt_pk_bf16_f32 v56, v136, v137
    v_cvt_pk_bf16_f32 v57, v138, v139
    v_cvt_pk_bf16_f32 v58, v140, v141
    v_cvt_pk_bf16_f32 v59, v142, v143
    buffer_store_dwordx4 v[56:59], v13, s[40:43], s77 offen offset:2560 sc1
    v_pk_mul_f32 v[128:129], v[64:65], v[254:255] op_sel_hi:[1,0]
    v_pk_mul_f32 v[130:131], v[66:67], v[254:255] op_sel_hi:[1,0]
    v_pk_mul_f32 v[132:133], v[68:69], v[254:255] op_sel_hi:[1,0]
    v_pk_mul_f32 v[134:135], v[70:71], v[254:255] op_sel_hi:[1,0]
    v_exp_f32 v128, v128
    v_exp_f32 v129, v129
    v_exp_f32 v130, v130
    v_exp_f32 v131, v131
    v_exp_f32 v132, v132
    v_exp_f32 v133, v133
    v_exp_f32 v134, v134
    v_exp_f32 v135, v135
    v_pk_add_f32 v[128:129], v[128:129], 1.0 op_sel_hi:[1,0]
    v_pk_add_f32 v[130:131], v[130:131], 1.0 op_sel_hi:[1,0]
    v_pk_add_f32 v[132:133], v[132:133], 1.0 op_sel_hi:[1,0]
    v_pk_add_f32 v[134:135], v[134:135], 1.0 op_sel_hi:[1,0]
    v_pk_fma_f32 v[128:129], v[128:129], v[128:129], 1.0 op_sel_hi:[1,1,0]
    v_pk_fma_f32 v[130:131], v[130:131], v[130:131], 1.0 op_sel_hi:[1,1,0]
    v_pk_fma_f32 v[132:133], v[132:133], v[132:133], 1.0 op_sel_hi:[1,1,0]
    v_pk_fma_f32 v[134:135], v[134:135], v[134:135], 1.0 op_sel_hi:[1,1,0]
    v_rcp_f32 v128, v128
    v_rcp_f32 v129, v129
    v_rcp_f32 v130, v130
    v_rcp_f32 v131, v131
    v_rcp_f32 v132, v132
    v_rcp_f32 v133, v133
    v_rcp_f32 v134, v134
    v_rcp_f32 v135, v135
    v_pk_fma_f32 v[128:129], v[128:129], v[252:253], v[252:253] op_sel:[0,1,0] op_sel_hi:[1,1,0]
    v_pk_fma_f32 v[130:131], v[130:131], v[252:253], v[252:253] op_sel:[0,1,0] op_sel_hi:[1,1,0]
    v_pk_fma_f32 v[132:133], v[132:133], v[252:253], v[252:253] op_sel:[0,1,0] op_sel_hi:[1,1,0]
    v_pk_fma_f32 v[134:135], v[134:135], v[252:253], v[252:253] op_sel:[0,1,0] op_sel_hi:[1,1,0]
    v_pk_mul_f32 v[128:129], v[128:129], v[64:65]
    v_pk_mul_f32 v[130:131], v[130:131], v[66:67]
    v_pk_mul_f32 v[132:133], v[132:133], v[68:69]
    v_pk_mul_f32 v[134:135], v[134:135], v[70:71]
    v_cvt_pk_bf16_f32 v64, v128, v129
    v_cvt_pk_bf16_f32 v65, v130, v131
    v_cvt_pk_bf16_f32 v66, v132, v133
    v_cvt_pk_bf16_f32 v67, v134, v135
    buffer_store_dwordx4 v[64:67], v13, s[40:43], s77 offen offset:3072 sc1
    v_pk_mul_f32 v[136:137], v[72:73], v[254:255] op_sel_hi:[1,0]
    v_pk_mul_f32 v[138:139], v[74:75], v[254:255] op_sel_hi:[1,0]
    v_pk_mul_f32 v[140:141], v[76:77], v[254:255] op_sel_hi:[1,0]
    v_pk_mul_f32 v[142:143], v[78:79], v[254:255] op_sel_hi:[1,0]
    v_exp_f32 v136, v136
    v_exp_f32 v137, v137
    v_exp_f32 v138, v138
    v_exp_f32 v139, v139
    v_exp_f32 v140, v140
    v_exp_f32 v141, v141
    v_exp_f32 v142, v142
    v_exp_f32 v143, v143
    v_pk_add_f32 v[136:137], v[136:137], 1.0 op_sel_hi:[1,0]
    v_pk_add_f32 v[138:139], v[138:139], 1.0 op_sel_hi:[1,0]
    v_pk_add_f32 v[140:141], v[140:141], 1.0 op_sel_hi:[1,0]
    v_pk_add_f32 v[142:143], v[142:143], 1.0 op_sel_hi:[1,0]
    v_pk_fma_f32 v[136:137], v[136:137], v[136:137], 1.0 op_sel_hi:[1,1,0]
    v_pk_fma_f32 v[138:139], v[138:139], v[138:139], 1.0 op_sel_hi:[1,1,0]
    v_pk_fma_f32 v[140:141], v[140:141], v[140:141], 1.0 op_sel_hi:[1,1,0]
    v_pk_fma_f32 v[142:143], v[142:143], v[142:143], 1.0 op_sel_hi:[1,1,0]
    v_rcp_f32 v136, v136
    v_rcp_f32 v137, v137
    v_rcp_f32 v138, v138
    v_rcp_f32 v139, v139
    v_rcp_f32 v140, v140
    v_rcp_f32 v141, v141
    v_rcp_f32 v142, v142
    v_rcp_f32 v143, v143
    v_pk_fma_f32 v[136:137], v[136:137], v[252:253], v[252:253] op_sel:[0,1,0] op_sel_hi:[1,1,0]
    v_pk_fma_f32 v[138:139], v[138:139], v[252:253], v[252:253] op_sel:[0,1,0] op_sel_hi:[1,1,0]
    v_pk_fma_f32 v[140:141], v[140:141], v[252:253], v[252:253] op_sel:[0,1,0] op_sel_hi:[1,1,0]
    v_pk_fma_f32 v[142:143], v[142:143], v[252:253], v[252:253] op_sel:[0,1,0] op_sel_hi:[1,1,0]
    v_pk_mul_f32 v[136:137], v[136:137], v[72:73]
    v_pk_mul_f32 v[138:139], v[138:139], v[74:75]
    v_pk_mul_f32 v[140:141], v[140:141], v[76:77]
    v_pk_mul_f32 v[142:143], v[142:143], v[78:79]
    v_cvt_pk_bf16_f32 v72, v136, v137
    v_cvt_pk_bf16_f32 v73, v138, v139
    v_cvt_pk_bf16_f32 v74, v140, v141
    v_cvt_pk_bf16_f32 v75, v142, v143
    buffer_store_dwordx4 v[72:75], v13, s[40:43], s77 offen offset:3584 sc1
    v_lshrrev_b32 v4, 5, v1
    v_bfe_u32 v7, v1, 2, 2
    v_lshl_add_u32 v14, v4, 2, v7
    v_bfe_u32 v5, v1, 4, 1
    v_lshlrev_b32 v5, 1, v5
    v_bfe_u32 v6, v1, 1, 1
    v_or_b32 v5, v5, v6
    v_bfe_u32 v6, v14, 1, 1
    v_lshlrev_b32 v6, 2, v6
    v_xor_b32 v5, v5, v6
    v_lshlrev_b32 v5, 4, v5
    v_and_b32 v6, 1, v1
    v_lshl_add_u32 v5, v6, 3, v5
    v_lshl_add_u32 v8, v14, 7, v5
    v_xor_b32 v9, 64, v8
    s_lshl_b32 s60, s56, 6
    s_mul_i32 s61, s56, 16384
    v_xor_b32 v8, s60, v8
    v_add_u32 v8, s61, v8
    v_xor_b32 v9, s60, v9
    v_add_u32 v9, s61, v9
    v_add_u32 v12, 65536, v8
    v_add_u32 v248, 114688, v8
    v_add_u32 v13, 65536, v9
    v_add_u32 v249, 114688, v9
    v_bfe_u32 v14, v1, 4, 1
    v_mul_u32_u24 v14, 57344, v14
    v_lshrrev_b32 v5, 5, v1
    v_lshl_add_u32 v14, v5, 8, v14
    v_and_b32 v5, 15, v1
    v_lshl_add_u32 v14, v5, 4, v14
    v_min_u32 v15, 6, v1
    v_lshlrev_b32 v15, 2, v15
    v_lshlrev_b32 v10, 4, v1
    s_lshl_b32 s60, s47, 12
    s_add_u32 s61, s60, 98304
    s_xor_b32 s60, s60, 0x2000
    s_add_u32 s60, s60, 98304
    v_add_u32 v11, s60, v10
    v_add_u32 v10, s61, v10
    s_lshl_b32 s60, s55, 2
    v_add_u32 v255, s60, v2
    v_and_b32 v5, 31, v1
    v_mul_u32_u24 v253, 896, v5
    v_lshrrev_b32 v5, 5, v1
    v_lshl_add_u32 v253, v5, 4, v253
    v_lshlrev_b32 v16, 16, v240
    v_and_b32 v17, 0xffff0000, v240
    v_lshlrev_b32 v18, 16, v241
    v_and_b32 v19, 0xffff0000, v241
    v_lshlrev_b32 v20, 16, v242
    v_and_b32 v21, 0xffff0000, v242
    v_lshlrev_b32 v22, 16, v243
    v_and_b32 v23, 0xffff0000, v243
    v_lshlrev_b32 v24, 16, v244
    v_and_b32 v25, 0xffff0000, v244
    v_lshlrev_b32 v26, 16, v245
    v_and_b32 v27, 0xffff0000, v245
    v_lshlrev_b32 v28, 16, v246
    v_and_b32 v29, 0xffff0000, v246
    v_lshlrev_b32 v30, 16, v247
    v_and_b32 v31, 0xffff0000, v247
    s_add_u32 s60, s65, 20480
    s_add_u32 s71, s65, 28672
    v_mov_b32 v5, 0
    v_mov_b32 v6, s48
    s_mov_b64 exec, 1
    s_waitcnt vmcnt(0)
    buffer_store_dword v6, v5, s[40:43], s60 offen
    s_mov_b64 exec, -1
    s_mov_b64 exec, 1
    ds_add_u32 v2, v3 offset:128
    s_mov_b64 exec, -1
    s_and_b32 s62, s51, 3
    s_mul_i32 s62, s62, 114688
    s_lshl_b32 s63, s44, 19
    s_add_u32 s62, s62, s63
    s_mul_i32 s63, s56, 28672
    s_add_u32 s62, s62, s63
    s_add_u32 s62, s62, 6291456
    s_lshl_b32 s65, s51, 7
    s_mul_i32 s63, s56, 28
    s_add_u32 s65, s65, s63
    s_mov_b32 s59, 0
cw_95:
    ds_read_b32 v4, v2 offset:64
    s_add_u32 s59, s59, 1
    s_lshr_b32 s3, s59, 20
    s_waitcnt lgkmcnt(0)
    v_readfirstlane_b32 s60, v4
    s_nop 0
    s_max_u32 s60, s60, s3
    s_cmp_lt_u32 s60, 4
    s_cbranch_scc1 cw_95
    ds_read_b64_tr_b16 v[52:53], v249 offset:0
    ds_read_b64_tr_b16 v[54:55], v249 offset:1024
    ds_read_b64_tr_b16 v[48:49], v248 offset:0
    ds_read_b64_tr_b16 v[50:51], v248 offset:1024
    ds_read_b64_tr_b16 v[60:61], v249 offset:2048
    ds_read_b64_tr_b16 v[62:63], v249 offset:3072
    ds_read_b64_tr_b16 v[56:57], v248 offset:2048
    ds_read_b64_tr_b16 v[58:59], v248 offset:3072
    ds_read_b64_tr_b16 v[68:69], v249 offset:4096
    ds_read_b64_tr_b16 v[70:71], v249 offset:5120
    ds_read_b64_tr_b16 v[64:65], v248 offset:4096
    ds_read_b64_tr_b16 v[66:67], v248 offset:5120
    s_mov_b32 s57, 16384
    s_add_u32 s60, s65, 20480
    s_add_u32 s61, s65, 28672
pf_96:
    s_mov_b32 s3, 24
pfi_98:
    buffer_load_dword v4, v15, s[40:43], s60 offen sc1
    s_sub_u32 s3, s3, 1
    s_waitcnt vmcnt(0)
    v_cmp_ne_u32 vcc, s48, v4
    s_cbranch_vccz pfd_97
    s_cbranch_scc0 pfi_98
    v_mov_b32 v5, 0
    v_mov_b32 v6, s48
    s_mov_b64 exec, 1
    buffer_store_dword v6, v5, s[40:43], s71 offen sc1
    s_mov_b64 exec, -1
    s_mov_b32 s71, 0x7f000000
    buffer_load_dword v4, v15, s[40:43], s61 offen sc1
    s_waitcnt vmcnt(0)
    v_cmp_ne_u32 vcc, s48, v4
    s_cbranch_vccz pfd_97
    s_sub_u32 s57, s57, 1
    s_cbranch_scc0 pf_96
pfd_97:
    s_add_u32 s64, s100, 0
    s_cmp_ge_u32 s64, 7
    s_cselect_b32 s63, 7, 0
    s_sub_u32 s64, s64, s63
    s_lshl_b32 s64, s64, 12
    s_add_u32 s64, s64, s62
    buffer_load_dwordx4 v[80:83], v14, s[40:43], s64 offen offset:0 sc1
    buffer_load_dwordx4 v[84:87], v14, s[40:43], s64 offen offset:512 sc1
    buffer_load_dwordx4 v[88:91], v14, s[40:43], s64 offen offset:1024 sc1
    buffer_load_dwordx4 v[92:95], v14, s[40:43], s64 offen offset:1536 sc1
    buffer_load_dwordx4 v[96:99], v14, s[40:43], s64 offen offset:2048 sc1
    buffer_load_dwordx4 v[100:103], v14, s[40:43], s64 offen offset:2560 sc1
    buffer_load_dwordx4 v[104:107], v14, s[40:43], s64 offen offset:3072 sc1
    buffer_load_dwordx4 v[108:111], v14, s[40:43], s64 offen offset:3584 sc1
    s_add_u32 s64, s100, 1
    s_cmp_ge_u32 s64, 7
    s_cselect_b32 s63, 7, 0
    s_sub_u32 s64, s64, s63
    s_lshl_b32 s64, s64, 12
    s_add_u32 s64, s64, s62
    buffer_load_dwordx4 v[112:115], v14, s[40:43], s64 offen offset:0 sc1
    buffer_load_dwordx4 v[116:119], v14, s[40:43], s64 offen offset:512 sc1
    s_waitcnt vmcnt(9)
    s_waitcnt lgkmcnt(8)
    v_mfma_f32_32x32x16_bf16 v[32:47], v[52:55], v[80:83], 0
    ds_read_b64_tr_b16 v[76:77], v249 offset:6144
    ds_read_b64_tr_b16 v[78:79], v249 offset:7168
    buffer_load_dwordx4 v[120:123], v14, s[40:43], s64 offen offset:1024 sc1
    v_mfma_f32_32x32x16_bf16 v[16:31], v[48:51], v[80:83], v[16:31]
    ds_read_b64_tr_b16 v[72:73], v248 offset:6144
    ds_read_b64_tr_b16 v[74:75], v248 offset:7168
    s_waitcnt vmcnt(9)
    s_waitcnt lgkmcnt(8)
    v_mfma_f32_32x32x16_bf16 v[32:47], v[60:63], v[84:87], v[32:47]
    ds_read_b64_tr_b16 v[52:53], v249 offset:8192
    ds_read_b64_tr_b16 v[54:55], v249 offset:9216
    buffer_load_dwordx4 v[124:127], v14, s[40:43], s64 offen offset:1536 sc1
    v_mfma_f32_32x32x16_bf16 v[16:31], v[56:59], v[84:87], v[16:31]
    ds_read_b64_tr_b16 v[48:49], v248 offset:8192
    ds_read_b64_tr_b16 v[50:51], v248 offset:9216
    s_waitcnt vmcnt(9)
    s_waitcnt lgkmcnt(8)
    v_mfma_f32_32x32x16_bf16 v[32:47], v[68:71], v[88:91], v[32:47]
    ds_read_b64_tr_b16 v[60:61], v249 offset:10240
    ds_read_b64_tr_b16 v[62:63], v249 offset:11264
    buffer_load_dwordx4 v[128:131], v14, s[40:43], s64 offen offset:2048 sc1
    v_mfma_f32_32x32x16_bf16 v[16:31], v[64:67], v[88:91], v[16:31]
    ds_read_b32 v252, v2 offset:68
    ds_read_b64_tr_b16 v[56:57], v248 offset:10240
    ds_read_b64_tr_b16 v[58:59], v248 offset:11264
    s_waitcnt vmcnt(9)
    s_waitcnt lgkmcnt(9)
    v_mfma_f32_32x32x16_bf16 v[32:47], v[76:79], v[92:95], v[32:47]
    ds_read_b64_tr_b16 v[68:69], v249 offset:12288
    ds_read_b64_tr_b16 v[70:71], v249 offset:13312
    buffer_load_dwordx4 v[132:135], v14, s[40:43], s64 offen offset:2560 sc1
    v_mfma_f32_32x32x16_bf16 v[16:31], v[72:75], v[92:95], v[16:31]
    ds_read_b64_tr_b16 v[64:65], v248 offset:12288
    ds_read_b64_tr_b16 v[66:67], v248 offset:13312
    s_waitcnt vmcnt(9)
    s_waitcnt lgkmcnt(9)
    v_mfma_f32_32x32x16_bf16 v[32:47], v[52:55], v[96:99], v[32:47]
    ds_read_b64_tr_b16 v[76:77], v249 offset:14336
    ds_read_b64_tr_b16 v[78:79], v249 offset:15360
    buffer_load_dwordx4 v[136:139], v14, s[40:43], s64 offen offset:3072 sc1
    v_mfma_f32_32x32x16_bf16 v[16:31], v[48:51], v[96:99], v[16:31]
    ds_read_b64_tr_b16 v[72:73], v248 offset:14336
    ds_read_b64_tr_b16 v[74:75], v248 offset:15360
    s_waitcnt vmcnt(9)
    s_waitcnt lgkmcnt(8)
    v_mfma_f32_32x32x16_bf16 v[32:47], v[60:63], v[100:103], v[32:47]
    v_readfirstlane_b32 s60, v252
    s_nop 0
    s_cmp_ge_u32 s60, 4
    s_cbranch_scc1 cc_99
    s_mov_b32 s59, 0
cw_100:
    ds_read_b32 v4, v2 offset:68
    s_add_u32 s59, s59, 1
    s_lshr_b32 s3, s59, 20
    s_waitcnt lgkmcnt(0)
    v_readfirstlane_b32 s60, v4
    s_nop 0
    s_max_u32 s60, s60, s3
    s_cmp_lt_u32 s60, 4
    s_cbranch_scc1 cw_100
cc_99:
    ds_read_b64_tr_b16 v[52:53], v9 offset:0
    ds_read_b64_tr_b16 v[54:55], v9 offset:1024
    buffer_load_dwordx4 v[140:143], v14, s[40:43], s64 offen offset:3584 sc1
    v_mfma_f32_32x32x16_bf16 v[16:31], v[56:59], v[100:103], v[16:31]
    ds_read_b64_tr_b16 v[48:49], v8 offset:0
    ds_read_b64_tr_b16 v[50:51], v8 offset:1024
    s_waitcnt vmcnt(9)
    s_waitcnt lgkmcnt(8)
    v_mfma_f32_32x32x16_bf16 v[32:47], v[68:71], v[104:107], v[32:47]
    ds_read_b64_tr_b16 v[60:61], v9 offset:2048
    ds_read_b64_tr_b16 v[62:63], v9 offset:3072
    s_add_u32 s64, s100, 2
    s_cmp_ge_u32 s64, 7
    s_cselect_b32 s63, 7, 0
    s_sub_u32 s64, s64, s63
    s_lshl_b32 s64, s64, 12
    s_add_u32 s64, s64, s62
    buffer_load_dwordx4 v[144:147], v14, s[40:43], s64 offen offset:0 sc1
    v_mfma_f32_32x32x16_bf16 v[16:31], v[64:67], v[104:107], v[16:31]
    ds_read_b64_tr_b16 v[56:57], v8 offset:2048
    ds_read_b64_tr_b16 v[58:59], v8 offset:3072
    s_waitcnt vmcnt(9)
    s_waitcnt lgkmcnt(8)
    v_mfma_f32_32x32x16_bf16 v[32:47], v[76:79], v[108:111], v[32:47]
    ds_read_b64_tr_b16 v[68:69], v9 offset:4096
    ds_read_b64_tr_b16 v[70:71], v9 offset:5120
    buffer_load_dwordx4 v[148:151], v14, s[40:43], s64 offen offset:512 sc1
    v_mfma_f32_32x32x16_bf16 v[16:31], v[72:75], v[108:111], v[16:31]
    ds_read_b64_tr_b16 v[64:65], v8 offset:4096
    ds_read_b64_tr_b16 v[66:67], v8 offset:5120
    s_mov_b64 exec, 1
    ds_add_u32 v2, v3 offset:96
    s_mov_b64 exec, -1
    s_waitcnt vmcnt(9)
    s_waitcnt lgkmcnt(9)
    v_mfma_f32_32x32x16_bf16 v[32:47], v[52:55], v[112:115], v[32:47]
    ds_read_b64_tr_b16 v[76:77], v9 offset:6144
    ds_read_b64_tr_b16 v[78:79], v9 offset:7168
    buffer_load_dwordx4 v[152:155], v14, s[40:43], s64 offen offset:1024 sc1
    v_mfma_f32_32x32x16_bf16 v[16:31], v[48:51], v[112:115], v[16:31]
    ds_read_b64_tr_b16 v[72:73], v8 offset:6144
    ds_read_b64_tr_b16 v[74:75], v8 offset:7168
    s_waitcnt vmcnt(9)
    s_waitcnt lgkmcnt(9)
    v_mfma_f32_32x32x16_bf16 v[32:47], v[60:63], v[116:119], v[32:47]
    ds_read_b64_tr_b16 v[52:53], v9 offset:8192
    ds_read_b64_tr_b16 v[54:55], v9 offset:9216
    buffer_load_dwordx4 v[156:159], v14, s[40:43], s64 offen offset:1536 sc1
    v_mfma_f32_32x32x16_bf16 v[16:31], v[56:59], v[116:119], v[16:31]
    ds_read_b64_tr_b16 v[48:49], v8 offset:8192
    ds_read_b64_tr_b16 v[50:51], v8 offset:9216
    s_waitcnt vmcnt(9)
    s_waitcnt lgkmcnt(9)
    v_mfma_f32_32x32x16_bf16 v[32:47], v[68:71], v[120:123], v[32:47]
    ds_read_b64_tr_b16 v[60:61], v9 offset:10240
    ds_read_b64_tr_b16 v[62:63], v9 offset:11264
    buffer_load_dwordx4 v[160:163], v14, s[40:43], s64 offen offset:2048 sc1
    v_mfma_f32_32x32x16_bf16 v[16:31], v[64:67], v[120:123], v[16:31]
    ds_read_b32 v252, v2 offset:72
    ds_read_b64_tr_b16 v[56:57], v8 offset:10240
    ds_read_b64_tr_b16 v[58:59], v8 offset:11264
    s_waitcnt vmcnt(9)
    s_waitcnt lgkmcnt(9)
    v_mfma_f32_32x32x16_bf16 v[32:47], v[76:79], v[124:127], v[32:47]
    ds_read_b64_tr_b16 v[68:69], v9 offset:12288
    ds_read_b64_tr_b16 v[70:71], v9 offset:13312
    buffer_load_dwordx4 v[164:167], v14, s[40:43], s64 offen offset:2560 sc1
    v_mfma_f32_32x32x16_bf16 v[16:31], v[72:75], v[124:127], v[16:31]
    ds_read_b64_tr_b16 v[64:65], v8 offset:12288
    ds_read_b64_tr_b16 v[66:67], v8 offset:13312
    s_waitcnt vmcnt(9)
    s_waitcnt lgkmcnt(9)
    v_mfma_f32_32x32x16_bf16 v[32:47], v[52:55], v[128:131], v[32:47]
    ds_read_b64_tr_b16 v[76:77], v9 offset:14336
    ds_read_b64_tr_b16 v[78:79], v9 offset:15360
    buffer_load_dwordx4 v[168:171], v14, s[40:43], s64 offen offset:3072 sc1
    v_mfma_f32_32x32x16_bf16 v[16:31], v[48:51], v[128:131], v[16:31]
    ds_read_b64_tr_b16 v[72:73], v8 offset:14336
    ds_read_b64_tr_b16 v[74:75], v8 offset:15360
    s_waitcnt vmcnt(9)
    s_waitcnt lgkmcnt(8)
    v_mfma_f32_32x32x16_bf16 v[32:47], v[60:63], v[132:135], v[32:47]
    v_readfirstlane_b32 s60, v252
    s_nop 0
    s_cmp_ge_u32 s60, 4
    s_cbranch_scc1 cc_101
    s_mov_b32 s59, 0
cw_102:
    ds_read_b32 v4, v2 offset:72
    s_add_u32 s59, s59, 1
    s_lshr_b32 s3, s59, 20
    s_waitcnt lgkmcnt(0)
    v_readfirstlane_b32 s60, v4
    s_nop 0
    s_max_u32 s60, s60, s3
    s_cmp_lt_u32 s60, 4
    s_cbranch_scc1 cw_102
cc_101:
    ds_read_b64_tr_b16 v[52:53], v9 offset:32768
    ds_read_b64_tr_b16 v[54:55], v9 offset:33792
    buffer_load_dwordx4 v[172:175], v14, s[40:43], s64 offen offset:3584 sc1
    v_mfma_f32_32x32x16_bf16 v[16:31], v[56:59], v[132:135], v[16:31]
    ds_read_b64_tr_b16 v[48:49], v8 offset:32768
    ds_read_b64_tr_b16 v[50:51], v8 offset:33792
    s_waitcnt vmcnt(9)
    s_waitcnt lgkmcnt(8)
    v_mfma_f32_32x32x16_bf16 v[32:47], v[68:71], v[136:139], v[32:47]
    ds_read_b64_tr_b16 v[60:61], v9 offset:34816
    ds_read_b64_tr_b16 v[62:63], v9 offset:35840
    s_add_u32 s64, s100, 3
    s_cmp_ge_u32 s64, 7
    s_cselect_b32 s63, 7, 0
    s_sub_u32 s64, s64, s63
    s_lshl_b32 s64, s64, 12
    s_add_u32 s64, s64, s62
    buffer_load_dwordx4 v[176:179], v14, s[40:43], s64 offen offset:0 sc1
    v_mfma_f32_32x32x16_bf16 v[16:31], v[64:67], v[136:139], v[16:31]
    ds_read_b64_tr_b16 v[56:57], v8 offset:34816
    ds_read_b64_tr_b16 v[58:59], v8 offset:35840
    s_waitcnt vmcnt(9)
    s_waitcnt lgkmcnt(8)
    v_mfma_f32_32x32x16_bf16 v[32:47], v[76:79], v[140:143], v[32:47]
    ds_read_b64_tr_b16 v[68:69], v9 offset:36864
    ds_read_b64_tr_b16 v[70:71], v9 offset:37888
    buffer_load_dwordx4 v[180:183], v14, s[40:43], s64 offen offset:512 sc1
    v_mfma_f32_32x32x16_bf16 v[16:31], v[72:75], v[140:143], v[16:31]
    ds_read_b64_tr_b16 v[64:65], v8 offset:36864
    ds_read_b64_tr_b16 v[66:67], v8 offset:37888
    s_mov_b64 exec, 1
    ds_add_u32 v2, v3 offset:100
    s_mov_b64 exec, -1
    s_waitcnt vmcnt(9)
    s_waitcnt lgkmcnt(9)
    v_mfma_f32_32x32x16_bf16 v[32:47], v[52:55], v[144:147], v[32:47]
    ds_read_b64_tr_b16 v[76:77], v9 offset:38912
    ds_read_b64_tr_b16 v[78:79], v9 offset:39936
    buffer_load_dwordx4 v[184:187], v14, s[40:43], s64 offen offset:1024 sc1
    v_mfma_f32_32x32x16_bf16 v[16:31], v[48:51], v[144:147], v[16:31]
    ds_read_b64_tr_b16 v[72:73], v8 offset:38912
    ds_read_b64_tr_b16 v[74:75], v8 offset:39936
    s_waitcnt vmcnt(9)
    s_waitcnt lgkmcnt(9)
    v_mfma_f32_32x32x16_bf16 v[32:47], v[60:63], v[148:151], v[32:47]
    ds_read_b64_tr_b16 v[52:53], v9 offset:40960
    ds_read_b64_tr_b16 v[54:55], v9 offset:41984
    buffer_load_dwordx4 v[188:191], v14, s[40:43], s64 offen offset:1536 sc1
    v_mfma_f32_32x32x16_bf16 v[16:31], v[56:59], v[148:151], v[16:31]
    ds_read_b64_tr_b16 v[48:49], v8 offset:40960
    ds_read_b64_tr_b16 v[50:51], v8 offset:41984
    s_waitcnt vmcnt(9)
    s_waitcnt lgkmcnt(9)
    v_mfma_f32_32x32x16_bf16 v[32:47], v[68:71], v[152:155], v[32:47]
    ds_read_b64_tr_b16 v[60:61], v9 offset:43008
    ds_read_b64_tr_b16 v[62:63], v9 offset:44032
    buffer_load_dwordx4 v[192:195], v14, s[40:43], s64 offen offset:2048 sc1
    v_mfma_f32_32x32x16_bf16 v[16:31], v[64:67], v[152:155], v[16:31]
    ds_read_b32 v252, v2 offset:76
    ds_read_b64_tr_b16 v[56:57], v8 offset:43008
    ds_read_b64_tr_b16 v[58:59], v8 offset:44032
    s_waitcnt vmcnt(9)
    s_waitcnt lgkmcnt(9)
    v_mfma_f32_32x32x16_bf16 v[32:47], v[76:79], v[156:159], v[32:47]
    ds_read_b64_tr_b16 v[68:69], v9 offset:45056
    ds_read_b64_tr_b16 v[70:71], v9 offset:46080
    buffer_load_dwordx4 v[196:199], v14, s[40:43], s64 offen offset:2560 sc1
    v_mfma_f32_32x32x16_bf16 v[16:31], v[72:75], v[156:159], v[16:31]
    ds_read_b64_tr_b16 v[64:65], v8 offset:45056
    ds_read_b64_tr_b16 v[66:67], v8 offset:46080
    s_waitcnt vmcnt(9)
    s_waitcnt lgkmcnt(9)
    v_mfma_f32_32x32x16_bf16 v[32:47], v[52:55], v[160:163], v[32:47]
    ds_read_b64_tr_b16 v[76:77], v9 offset:47104
    ds_read_b64_tr_b16 v[78:79], v9 offset:48128
    buffer_load_dwordx4 v[200:203], v14, s[40:43], s64 offen offset:3072 sc1
    v_mfma_f32_32x32x16_bf16 v[16:31], v[48:51], v[160:163], v[16:31]
    ds_read_b64_tr_b16 v[72:73], v8 offset:47104
    ds_read_b64_tr_b16 v[74:75], v8 offset:48128
    s_waitcnt vmcnt(9)
    s_waitcnt lgkmcnt(8)
    v_mfma_f32_32x32x16_bf16 v[32:47], v[60:63], v[164:167], v[32:47]
    v_readfirstlane_b32 s60, v252
    s_nop 0
    s_cmp_ge_u32 s60, 4
    s_cbranch_scc1 cc_103
    s_mov_b32 s59, 0
cw_104:
    ds_read_b32 v4, v2 offset:76
    s_add_u32 s59, s59, 1
    s_lshr_b32 s3, s59, 20
    s_waitcnt lgkmcnt(0)
    v_readfirstlane_b32 s60, v4
    s_nop 0
    s_max_u32 s60, s60, s3
    s_cmp_lt_u32 s60, 4
    s_cbranch_scc1 cw_104
cc_103:
    ds_read_b64_tr_b16 v[52:53], v13 offset:0
    ds_read_b64_tr_b16 v[54:55], v13 offset:1024
    buffer_load_dwordx4 v[204:207], v14, s[40:43], s64 offen offset:3584 sc1
    v_mfma_f32_32x32x16_bf16 v[16:31], v[56:59], v[164:167], v[16:31]
    ds_read_b64_tr_b16 v[48:49], v12 offset:0
    ds_read_b64_tr_b16 v[50:51], v12 offset:1024
    s_waitcnt vmcnt(9)
    s_waitcnt lgkmcnt(8)
    v_mfma_f32_32x32x16_bf16 v[32:47], v[68:71], v[168:171], v[32:47]
    ds_read_b64_tr_b16 v[60:61], v13 offset:2048
    ds_read_b64_tr_b16 v[62:63], v13 offset:3072
    s_add_u32 s64, s100, 4
    s_cmp_ge_u32 s64, 7
    s_cselect_b32 s63, 7, 0
    s_sub_u32 s64, s64, s63
    s_lshl_b32 s64, s64, 12
    s_add_u32 s64, s64, s62
    buffer_load_dwordx4 v[80:83], v14, s[40:43], s64 offen offset:0 sc1
    v_mfma_f32_32x32x16_bf16 v[16:31], v[64:67], v[168:171], v[16:31]
    ds_read_b64_tr_b16 v[56:57], v12 offset:2048
    ds_read_b64_tr_b16 v[58:59], v12 offset:3072
    s_waitcnt vmcnt(9)
    s_waitcnt lgkmcnt(8)
    v_mfma_f32_32x32x16_bf16 v[32:47], v[76:79], v[172:175], v[32:47]
    ds_read_b64_tr_b16 v[68:69], v13 offset:4096
    ds_read_b64_tr_b16 v[70:71], v13 offset:5120
    buffer_load_dwordx4 v[84:87], v14, s[40:43], s64 offen offset:512 sc1
    v_mfma_f32_32x32x16_bf16 v[16:31], v[72:75], v[172:175], v[16:31]
    ds_read_b64_tr_b16 v[64:65], v12 offset:4096
    ds_read_b64_tr_b16 v[66:67], v12 offset:5120
    s_mov_b64 exec, 1
    ds_add_u32 v2, v3 offset:104
    s_mov_b64 exec, -1
    s_waitcnt vmcnt(9)
    s_waitcnt lgkmcnt(9)
    v_mfma_f32_32x32x16_bf16 v[32:47], v[52:55], v[176:179], v[32:47]
    ds_read_b64_tr_b16 v[76:77], v13 offset:6144
    ds_read_b64_tr_b16 v[78:79], v13 offset:7168
    buffer_load_dwordx4 v[88:91], v14, s[40:43], s64 offen offset:1024 sc1
    v_mfma_f32_32x32x16_bf16 v[16:31], v[48:51], v[176:179], v[16:31]
    ds_read_b64_tr_b16 v[72:73], v12 offset:6144
    ds_read_b64_tr_b16 v[74:75], v12 offset:7168
    s_waitcnt vmcnt(9)
    s_waitcnt lgkmcnt(9)
    v_mfma_f32_32x32x16_bf16 v[32:47], v[60:63], v[180:183], v[32:47]
    ds_read_b64_tr_b16 v[52:53], v13 offset:8192
    ds_read_b64_tr_b16 v[54:55], v13 offset:9216
    buffer_load_dwordx4 v[92:95], v14, s[40:43], s64 offen offset:1536 sc1
    v_mfma_f32_32x32x16_bf16 v[16:31], v[56:59], v[180:183], v[16:31]
    ds_read_b64_tr_b16 v[48:49], v12 offset:8192
    ds_read_b64_tr_b16 v[50:51], v12 offset:9216
    s_waitcnt vmcnt(9)
    s_waitcnt lgkmcnt(9)
    v_mfma_f32_32x32x16_bf16 v[32:47], v[68:71], v[184:187], v[32:47]
    ds_read_b64_tr_b16 v[60:61], v13 offset:10240
    ds_read_b64_tr_b16 v[62:63], v13 offset:11264
    buffer_load_dwordx4 v[96:99], v14, s[40:43], s64 offen offset:2048 sc1
    v_mfma_f32_32x32x16_bf16 v[16:31], v[64:67], v[184:187], v[16:31]
    ds_read_b32 v252, v2 offset:80
    ds_read_b64_tr_b16 v[56:57], v12 offset:10240
    ds_read_b64_tr_b16 v[58:59], v12 offset:11264
    s_waitcnt vmcnt(9)
    s_waitcnt lgkmcnt(9)
    v_mfma_f32_32x32x16_bf16 v[32:47], v[76:79], v[188:191], v[32:47]
    ds_read_b64_tr_b16 v[68:69], v13 offset:12288
    ds_read_b64_tr_b16 v[70:71], v13 offset:13312
    buffer_load_dwordx4 v[100:103], v14, s[40:43], s64 offen offset:2560 sc1
    v_mfma_f32_32x32x16_bf16 v[16:31], v[72:75], v[188:191], v[16:31]
    ds_read_b64_tr_b16 v[64:65], v12 offset:12288
    ds_read_b64_tr_b16 v[66:67], v12 offset:13312
    s_waitcnt vmcnt(9)
    s_waitcnt lgkmcnt(9)
    v_mfma_f32_32x32x16_bf16 v[32:47], v[52:55], v[192:195], v[32:47]
    ds_read_b64_tr_b16 v[76:77], v13 offset:14336
    ds_read_b64_tr_b16 v[78:79], v13 offset:15360
    buffer_load_dwordx4 v[104:107], v14, s[40:43], s64 offen offset:3072 sc1
    v_mfma_f32_32x32x16_bf16 v[16:31], v[48:51], v[192:195], v[16:31]
    ds_read_b64_tr_b16 v[72:73], v12 offset:14336
    ds_read_b64_tr_b16 v[74:75], v12 offset:15360
    s_waitcnt vmcnt(9)
    s_waitcnt lgkmcnt(8)
    v_mfma_f32_32x32x16_bf16 v[32:47], v[60:63], v[196:199], v[32:47]
    v_readfirstlane_b32 s60, v252
    s_nop 0
    s_cmp_ge_u32 s60, 4
    s_cbranch_scc1 cc_105
    s_mov_b32 s59, 0
cw_106:
    ds_read_b32 v4, v2 offset:80
    s_add_u32 s59, s59, 1
    s_lshr_b32 s3, s59, 20
    s_waitcnt lgkmcnt(0)
    v_readfirstlane_b32 s60, v4
    s_nop 0
    s_max_u32 s60, s60, s3
    s_cmp_lt_u32 s60, 4
    s_cbranch_scc1 cw_106
cc_105:
    ds_read_b64_tr_b16 v[52:53], v249 offset:0
    ds_read_b64_tr_b16 v[54:55], v249 offset:1024
    buffer_load_dwordx4 v[108:111], v14, s[40:43], s64 offen offset:3584 sc1
    v_mfma_f32_32x32x16_bf16 v[16:31], v[56:59], v[196:199], v[16:31]
    ds_read_b64_tr_b16 v[48:49], v248 offset:0
    ds_read_b64_tr_b16 v[50:51], v248 offset:1024
    s_waitcnt vmcnt(9)
    s_waitcnt lgkmcnt(8)
    v_mfma_f32_32x32x16_bf16 v[32:47], v[68:71], v[200:203], v[32:47]
    ds_read_b64_tr_b16 v[60:61], v249 offset:2048
    ds_read_b64_tr_b16 v[62:63], v249 offset:3072
    s_add_u32 s64, s100, 5
    s_cmp_ge_u32 s64, 7
    s_cselect_b32 s63, 7, 0
    s_sub_u32 s64, s64, s63
    s_lshl_b32 s64, s64, 12
    s_add_u32 s64, s64, s62
    buffer_load_dwordx4 v[112:115], v14, s[40:43], s64 offen offset:0 sc1
    v_mfma_f32_32x32x16_bf16 v[16:31], v[64:67], v[200:203], v[16:31]
    ds_read_b64_tr_b16 v[56:57], v248 offset:2048
    ds_read_b64_tr_b16 v[58:59], v248 offset:3072
    s_waitcnt vmcnt(9)
    s_waitcnt lgkmcnt(8)
    v_mfma_f32_32x32x16_bf16 v[32:47], v[76:79], v[204:207], v[32:47]
    ds_read_b64_tr_b16 v[68:69], v249 offset:4096
    ds_read_b64_tr_b16 v[70:71], v249 offset:5120
    buffer_load_dwordx4 v[116:119], v14, s[40:43], s64 offen offset:512 sc1
    v_mfma_f32_32x32x16_bf16 v[16:31], v[72:75], v[204:207], v[16:31]
    ds_read_b64_tr_b16 v[64:65], v248 offset:4096
    ds_read_b64_tr_b16 v[66:67], v248 offset:5120
    s_waitcnt vmcnt(9)
    s_waitcnt lgkmcnt(8)
    v_mfma_f32_32x32x16_bf16 v[32:47], v[52:55], v[80:83], v[32:47]
    ds_read_b64_tr_b16 v[76:77], v249 offset:6144
    ds_read_b64_tr_b16 v[78:79], v249 offset:7168
    buffer_load_dwordx4 v[120:123], v14, s[40:43], s64 offen offset:1024 sc1
    v_mfma_f32_32x32x16_bf16 v[16:31], v[48:51], v[80:83], v[16:31]
    ds_read_b64_tr_b16 v[72:73], v248 offset:6144
    ds_read_b64_tr_b16 v[74:75], v248 offset:7168
    s_waitcnt vmcnt(9)
    s_waitcnt lgkmcnt(8)
    v_mfma_f32_32x32x16_bf16 v[32:47], v[60:63], v[84:87], v[32:47]
    ds_read_b64_tr_b16 v[52:53], v249 offset:8192
    ds_read_b64_tr_b16 v[54:55], v249 offset:9216
    buffer_load_dwordx4 v[124:127], v14, s[40:43], s64 offen offset:1536 sc1
    v_mfma_f32_32x32x16_bf16 v[16:31], v[56:59], v[84:87], v[16:31]
    ds_read_b64_tr_b16 v[48:49], v248 offset:8192
    ds_read_b64_tr_b16 v[50:51], v248 offset:9216
    s_waitcnt vmcnt(9)
    s_waitcnt lgkmcnt(8)
    v_mfma_f32_32x32x16_bf16 v[32:47], v[68:71], v[88:91], v[32:47]
    ds_read_b64_tr_b16 v[60:61], v249 offset:10240
    ds_read_b64_tr_b16 v[62:63], v249 offset:11264
    buffer_load_dwordx4 v[128:131], v14, s[40:43], s64 offen offset:2048 sc1
    v_mfma_f32_32x32x16_bf16 v[16:31], v[64:67], v[88:91], v[16:31]
    ds_read_b32 v252, v2 offset:84
    ds_read_b64_tr_b16 v[56:57], v248 offset:10240
    ds_read_b64_tr_b16 v[58:59], v248 offset:11264
    s_waitcnt vmcnt(9)
    s_waitcnt lgkmcnt(9)
    v_mfma_f32_32x32x16_bf16 v[32:47], v[76:79], v[92:95], v[32:47]
    ds_read_b64_tr_b16 v[68:69], v249 offset:12288
    ds_read_b64_tr_b16 v[70:71], v249 offset:13312
    buffer_load_dwordx4 v[132:135], v14, s[40:43], s64 offen offset:2560 sc1
    v_mfma_f32_32x32x16_bf16 v[16:31], v[72:75], v[92:95], v[16:31]
    ds_read_b64_tr_b16 v[64:65], v248 offset:12288
    ds_read_b64_tr_b16 v[66:67], v248 offset:13312
    s_waitcnt vmcnt(9)
    s_waitcnt lgkmcnt(9)
    v_mfma_f32_32x32x16_bf16 v[32:47], v[52:55], v[96:99], v[32:47]
    ds_read_b64_tr_b16 v[76:77], v249 offset:14336
    ds_read_b64_tr_b16 v[78:79], v249 offset:15360
    buffer_load_dwordx4 v[136:139], v14, s[40:43], s64 offen offset:3072 sc1
    v_mfma_f32_32x32x16_bf16 v[16:31], v[48:51], v[96:99], v[16:31]
    ds_read_b64_tr_b16 v[72:73], v248 offset:14336
    ds_read_b64_tr_b16 v[74:75], v248 offset:15360
    s_waitcnt vmcnt(9)
    s_waitcnt lgkmcnt(8)
    v_mfma_f32_32x32x16_bf16 v[32:47], v[60:63], v[100:103], v[32:47]
    v_readfirstlane_b32 s60, v252
    s_nop 0
    s_cmp_ge_u32 s60, 4
    s_cbranch_scc1 cc_107
    s_mov_b32 s59, 0
cw_108:
    ds_read_b32 v4, v2 offset:84
    s_add_u32 s59, s59, 1
    s_lshr_b32 s3, s59, 20
    s_waitcnt lgkmcnt(0)
    v_readfirstlane_b32 s60, v4
    s_nop 0
    s_max_u32 s60, s60, s3
    s_cmp_lt_u32 s60, 4
    s_cbranch_scc1 cw_108
cc_107:
    ds_read_b64_tr_b16 v[52:53], v9 offset:0
    ds_read_b64_tr_b16 v[54:55], v9 offset:1024
    buffer_load_dwordx4 v[140:143], v14, s[40:43], s64 offen offset:3584 sc1
    v_mfma_f32_32x32x16_bf16 v[16:31], v[56:59], v[100:103], v[16:31]
    ds_read_b64_tr_b16 v[48:49], v8 offset:0
    ds_read_b64_tr_b16 v[50:51], v8 offset:1024
    s_waitcnt vmcnt(9)
    s_waitcnt lgkmcnt(8)
    v_mfma_f32_32x32x16_bf16 v[32:47], v[68:71], v[104:107], v[32:47]
    ds_read_b64_tr_b16 v[60:61], v9 offset:2048
    ds_read_b64_tr_b16 v[62:63], v9 offset:3072
    s_add_u32 s64, s100, 6
    s_cmp_ge_u32 s64, 7
    s_cselect_b32 s63, 7, 0
    s_sub_u32 s64, s64, s63
    s_lshl_b32 s64, s64, 12
    s_add_u32 s64, s64, s62
    buffer_load_dwordx4 v[144:147], v14, s[40:43], s64 offen offset:0 sc1
    v_mfma_f32_32x32x16_bf16 v[16:31], v[64:67], v[104:107], v[16:31]
    ds_read_b64_tr_b16 v[56:57], v8 offset:2048
    ds_read_b64_tr_b16 v[58:59], v8 offset:3072
    s_waitcnt vmcnt(9)
    s_waitcnt lgkmcnt(8)
    v_mfma_f32_32x32x16_bf16 v[32:47], v[76:79], v[108:111], v[32:47]
    ds_read_b64_tr_b16 v[68:69], v9 offset:4096
    ds_read_b64_tr_b16 v[70:71], v9 offset:5120
    buffer_load_dwordx4 v[148:151], v14, s[40:43], s64 offen offset:512 sc1
    v_mfma_f32_32x32x16_bf16 v[16:31], v[72:75], v[108:111], v[16:31]
    ds_read_b64_tr_b16 v[64:65], v8 offset:4096
    ds_read_b64_tr_b16 v[66:67], v8 offset:5120
    s_waitcnt vmcnt(9)
    s_waitcnt lgkmcnt(8)
    v_mfma_f32_32x32x16_bf16 v[32:47], v[52:55], v[112:115], v[32:47]
    ds_read_b64_tr_b16 v[76:77], v9 offset:6144
    ds_read_b64_tr_b16 v[78:79], v9 offset:7168
    buffer_load_dwordx4 v[152:155], v14, s[40:43], s64 offen offset:1024 sc1
    v_mfma_f32_32x32x16_bf16 v[16:31], v[48:51], v[112:115], v[16:31]
    ds_read_b64_tr_b16 v[72:73], v8 offset:6144
    ds_read_b64_tr_b16 v[74:75], v8 offset:7168
    s_waitcnt vmcnt(9)
    s_waitcnt lgkmcnt(8)
    v_mfma_f32_32x32x16_bf16 v[32:47], v[60:63], v[116:119], v[32:47]
    ds_read_b64_tr_b16 v[52:53], v9 offset:8192
    ds_read_b64_tr_b16 v[54:55], v9 offset:9216
    buffer_load_dwordx4 v[156:159], v14, s[40:43], s64 offen offset:1536 sc1
    v_mfma_f32_32x32x16_bf16 v[16:31], v[56:59], v[116:119], v[16:31]
    ds_read_b64_tr_b16 v[48:49], v8 offset:8192
    ds_read_b64_tr_b16 v[50:51], v8 offset:9216
    s_waitcnt vmcnt(9)
    s_waitcnt lgkmcnt(8)
    v_mfma_f32_32x32x16_bf16 v[32:47], v[68:71], v[120:123], v[32:47]
    ds_read_b64_tr_b16 v[60:61], v9 offset:10240
    ds_read_b64_tr_b16 v[62:63], v9 offset:11264
    buffer_load_dwordx4 v[160:163], v14, s[40:43], s64 offen offset:2048 sc1
    v_mfma_f32_32x32x16_bf16 v[16:31], v[64:67], v[120:123], v[16:31]
    ds_read_b32 v252, v2 offset:88
    ds_read_b64_tr_b16 v[56:57], v8 offset:10240
    ds_read_b64_tr_b16 v[58:59], v8 offset:11264
    s_waitcnt vmcnt(9)
    s_waitcnt lgkmcnt(9)
    v_mfma_f32_32x32x16_bf16 v[32:47], v[76:79], v[124:127], v[32:47]
    ds_read_b64_tr_b16 v[68:69], v9 offset:12288
    ds_read_b64_tr_b16 v[70:71], v9 offset:13312
    buffer_load_dwordx4 v[164:167], v14, s[40:43], s64 offen offset:2560 sc1
    v_mfma_f32_32x32x16_bf16 v[16:31], v[72:75], v[124:127], v[16:31]
    ds_read_b64_tr_b16 v[64:65], v8 offset:12288
    ds_read_b64_tr_b16 v[66:67], v8 offset:13312
    s_waitcnt vmcnt(9)
    s_waitcnt lgkmcnt(9)
    v_mfma_f32_32x32x16_bf16 v[32:47], v[52:55], v[128:131], v[32:47]
    ds_read_b64_tr_b16 v[76:77], v9 offset:14336
    ds_read_b64_tr_b16 v[78:79], v9 offset:15360
    buffer_load_dwordx4 v[168:171], v14, s[40:43], s64 offen offset:3072 sc1
    v_mfma_f32_32x32x16_bf16 v[16:31], v[48:51], v[128:131], v[16:31]
    ds_read_b64_tr_b16 v[72:73], v8 offset:14336
    ds_read_b64_tr_b16 v[74:75], v8 offset:15360
    s_waitcnt vmcnt(9)
    s_waitcnt lgkmcnt(8)
    v_mfma_f32_32x32x16_bf16 v[32:47], v[60:63], v[132:135], v[32:47]
    v_readfirstlane_b32 s60, v252
    s_nop 0
    s_cmp_ge_u32 s60, 4
    s_cbranch_scc1 cc_109
    s_mov_b32 s59, 0
cw_110:
    ds_read_b32 v4, v2 offset:88
    s_add_u32 s59, s59, 1
    s_lshr_b32 s3, s59, 20
    s_waitcnt lgkmcnt(0)
    v_readfirstlane_b32 s60, v4
    s_nop 0
    s_max_u32 s60, s60, s3
    s_cmp_lt_u32 s60, 4
    s_cbranch_scc1 cw_110
cc_109:
    ds_read_b64_tr_b16 v[52:53], v9 offset:32768
    ds_read_b64_tr_b16 v[54:55], v9 offset:33792
    buffer_load_dwordx4 v[172:175], v14, s[40:43], s64 offen offset:3584 sc1
    v_mfma_f32_32x32x16_bf16 v[16:31], v[56:59], v[132:135], v[16:31]
    ds_read_b64_tr_b16 v[48:49], v8 offset:32768
    ds_read_b64_tr_b16 v[50:51], v8 offset:33792
    s_waitcnt vmcnt(9)
    s_waitcnt lgkmcnt(8)
    v_mfma_f32_32x32x16_bf16 v[32:47], v[68:71], v[136:139], v[32:47]
    ds_read_b64_tr_b16 v[60:61], v9 offset:34816
    ds_read_b64_tr_b16 v[62:63], v9 offset:35840
    v_mfma_f32_32x32x16_bf16 v[16:31], v[64:67], v[136:139], v[16:31]
    ds_read_b64_tr_b16 v[56:57], v8 offset:34816
    ds_read_b64_tr_b16 v[58:59], v8 offset:35840
    v_mov_b32 v5, 0
    v_mov_b32 v6, s48
    s_mov_b64 exec, 1
    buffer_store_dword v6, v5, s[40:43], s71 offen sc1
    s_mov_b64 exec, -1
    s_mov_b32 s71, 0x7f000000
    s_waitcnt vmcnt(9)
    s_waitcnt lgkmcnt(8)
    v_mfma_f32_32x32x16_bf16 v[32:47], v[76:79], v[140:143], v[32:47]
    ds_read_b64_tr_b16 v[68:69], v9 offset:36864
    ds_read_b64_tr_b16 v[70:71], v9 offset:37888
    v_mfma_f32_32x32x16_bf16 v[16:31], v[72:75], v[140:143], v[16:31]
    ds_read_b64_tr_b16 v[64:65], v8 offset:36864
    ds_read_b64_tr_b16 v[66:67], v8 offset:37888
    s_waitcnt vmcnt(8)
    s_waitcnt lgkmcnt(8)
    v_mfma_f32_32x32x16_bf16 v[32:47], v[52:55], v[144:147], v[32:47]
    ds_read_b64_tr_b16 v[76:77], v9 offset:38912
    ds_read_b64_tr_b16 v[78:79], v9 offset:39936
    v_mfma_f32_32x32x16_bf16 v[16:31], v[48:51], v[144:147], v[16:31]
    ds_read_b64_tr_b16 v[72:73], v8 offset:38912
    ds_read_b64_tr_b16 v[74:75], v8 offset:39936
    s_waitcnt vmcnt(7)
    s_waitcnt lgkmcnt(8)
    v_mfma_f32_32x32x16_bf16 v[32:47], v[60:63], v[148:151], v[32:47]
    ds_read_b64_tr_b16 v[52:53], v9 offset:40960
    ds_read_b64_tr_b16 v[54:55], v9 offset:41984
    v_mfma_f32_32x32x16_bf16 v[16:31], v[56:59], v[148:151], v[16:31]
    ds_read_b64_tr_b16 v[48:49], v8 offset:40960
    ds_read_b64_tr_b16 v[50:51], v8 offset:41984
    s_waitcnt vmcnt(6)
    s_waitcnt lgkmcnt(8)
    v_mfma_f32_32x32x16_bf16 v[32:47], v[68:71], v[152:155], v[32:47]
    ds_read_b64_tr_b16 v[60:61], v9 offset:43008
    ds_read_b64_tr_b16 v[62:63], v9 offset:44032
    v_mfma_f32_32x32x16_bf16 v[16:31], v[64:67], v[152:155], v[16:31]
    ds_read_b64_tr_b16 v[56:57], v8 offset:43008
    ds_read_b64_tr_b16 v[58:59], v8 offset:44032
    s_waitcnt vmcnt(5)
    s_waitcnt lgkmcnt(8)
    v_mfma_f32_32x32x16_bf16 v[32:47], v[76:79], v[156:159], v[32:47]
    ds_read_b64_tr_b16 v[68:69], v9 offset:45056
    ds_read_b64_tr_b16 v[70:71], v9 offset:46080
    v_mfma_f32_32x32x16_bf16 v[16:31], v[72:75], v[156:159], v[16:31]
    ds_read_b64_tr_b16 v[64:65], v8 offset:45056
    ds_read_b64_tr_b16 v[66:67], v8 offset:46080
    s_waitcnt vmcnt(4)
    s_waitcnt lgkmcnt(8)
    v_mfma_f32_32x32x16_bf16 v[32:47], v[52:55], v[160:163], v[32:47]
    ds_read_b64_tr_b16 v[76:77], v9 offset:47104
    ds_read_b64_tr_b16 v[78:79], v9 offset:48128
    v_mfma_f32_32x32x16_bf16 v[16:31], v[48:51], v[160:163], v[16:31]
    ds_read_b64_tr_b16 v[72:73], v8 offset:47104
    ds_read_b64_tr_b16 v[74:75], v8 offset:48128
    s_waitcnt vmcnt(3)
    s_waitcnt lgkmcnt(8)
    v_mfma_f32_32x32x16_bf16 v[32:47], v[60:63], v[164:167], v[32:47]
    v_mfma_f32_32x32x16_bf16 v[16:31], v[56:59], v[164:167], v[16:31]
    s_waitcnt vmcnt(2)
    s_waitcnt lgkmcnt(4)
    v_mfma_f32_32x32x16_bf16 v[32:47], v[68:71], v[168:171], v[32:47]
    v_mfma_f32_32x32x16_bf16 v[16:31], v[64:67], v[168:171], v[16:31]
    s_waitcnt vmcnt(1)
    s_waitcnt lgkmcnt(0)
    v_mfma_f32_32x32x16_bf16 v[32:47], v[76:79], v[172:175], v[32:47]
    v_mfma_f32_32x32x16_bf16 v[16:31], v[72:75], v[172:175], v[16:31]
    s_nop 10
    ds_write_b128 v10, v[32:35] offset:0
    ds_write_b128 v10, v[36:39] offset:1024
    ds_write_b128 v10, v[40:43] offset:2048
    ds_write_b128 v10, v[44:47] offset:3072
    s_waitcnt lgkmcnt(0)
    s_mov_b64 exec, 1
    ds_add_u32 v255, v3 offset:48
    s_mov_b64 exec, -1
    s_mov_b32 s59, 0
cw_111:
    ds_read_b32 v4, v255 offset:48
    s_add_u32 s59, s59, 1
    s_lshr_b32 s3, s59, 20
    s_waitcnt lgkmcnt(0)
    v_readfirstlane_b32 s60, v4
    s_nop 0
    s_max_u32 s60, s60, s3
    s_cmp_lt_u32 s60, 2
    s_cbranch_scc1 cw_111
    ds_read_b128 v[32:35], v11 offset:0
    ds_read_b128 v[36:39], v11 offset:1024
    ds_read_b128 v[40:43], v11 offset:2048
    ds_read_b128 v[44:47], v11 offset:3072
    s_waitcnt lgkmcnt(3)
    v_pk_add_f32 v[16:17], v[16:17], v[32:33]
    v_pk_add_f32 v[18:19], v[18:19], v[34:35]
    v_cvt_pk_bf16_f32 v240, v16, v17
    v_cvt_pk_bf16_f32 v241, v18, v19
    s_waitcnt lgkmcnt(2)
    v_pk_add_f32 v[20:21], v[20:21], v[36:37]
    v_pk_add_f32 v[22:23], v[22:23], v[38:39]
    v_cvt_pk_bf16_f32 v242, v20, v21
    v_cvt_pk_bf16_f32 v243, v22, v23
    s_nop 0
    v_permlane32_swap_b32 v240, v242
    v_permlane32_swap_b32 v241, v243
    buffer_store_dwordx4 v[240:243], v253, s[36:39], s79 offen offset:0
    s_waitcnt lgkmcnt(1)
    v_pk_add_f32 v[24:25], v[24:25], v[40:41]
    v_pk_add_f32 v[26:27], v[26:27], v[42:43]
    v_cvt_pk_bf16_f32 v244, v24, v25
    v_cvt_pk_bf16_f32 v245, v26, v27
    s_waitcnt lgkmcnt(0)
    v_pk_add_f32 v[28:29], v[28:29], v[44:45]
    v_pk_add_f32 v[30:31], v[30:31], v[46:47]
    v_cvt_pk_bf16_f32 v246, v28, v29
    v_cvt_pk_bf16_f32 v247, v30, v31
    s_nop 0
    v_permlane32_swap_b32 v244, v246
    v_permlane32_swap_b32 v245, v247
    buffer_store_dwordx4 v[244:247], v253, s[36:39], s79 offen offset:32
    s_or_b32 s60, s2, s47
    s_cmp_lg_u32 s60, 0
    s_cbranch_scc1 L_Aexit
    v_mov_b32 v5, 12
    v_mov_b32 v6, s48
    buffer_store_dword v6, v5, s[40:43], 0 offen
L_Aexit:
    s_endpgm
L_roleB:
    s_setprio 2
    v_mov_b32 v184, 0
    v_mov_b32 v185, 0
    v_mov_b32 v186, 0
    v_mov_b32 v187, 0
    v_mov_b32 v193, 0
    v_mov_b32 v195, 0
    v_mov_b32 v191, 0
    v_mov_b32 v198, 0
    v_mov_b32 v199, 0
    s_waitcnt vmcnt(3)
    s_waitcnt lgkmcnt(0)
    s_barrier
    ds_read_b128 v[16:19], v12 offset:0
    ds_read_b128 v[20:23], v13 offset:0
    ds_read_b128 v[24:27], v14 offset:0
    ds_read_b128 v[28:31], v15 offset:0
    s_lshl_b32 s60, s68, 7
    s_add_u32 s60, s60, s51
    s_add_u32 m0, s76, 32768
    s_nop 0
    buffer_load_dwordx4 v8, s[8:11], s60 offen lds
    s_add_u32 m0, s76, 33792
    s_nop 0
    buffer_load_dwordx4 v9, s[8:11], s60 offen lds
    s_lshl_b32 s60, s69, 7
    s_add_u32 s60, s60, s51
    s_add_u32 m0, s76, 49152
    s_nop 0
    buffer_load_dwordx4 v8, s[8:11], s60 offen lds
    s_add_u32 m0, s76, 50176
    s_nop 0
    buffer_load_dwordx4 v9, s[8:11], s60 offen lds
    s_waitcnt vmcnt(5)
    s_waitcnt lgkmcnt(0)
    s_barrier
    v_dot2c_f32_bf16 v184, s73, v16
    v_dot2c_f32_bf16 v186, v16, v16
    v_dot2c_f32_bf16 v185, s73, v17
    v_dot2c_f32_bf16 v187, v17, v17
    v_dot2c_f32_bf16 v184, s73, v18
    v_dot2c_f32_bf16 v186, v18, v18
    v_dot2c_f32_bf16 v185, s73, v19
    v_dot2c_f32_bf16 v187, v19, v19
    v_dot2c_f32_bf16 v184, s73, v20
    v_dot2c_f32_bf16 v186, v20, v20
    v_dot2c_f32_bf16 v185, s73, v21
    v_dot2c_f32_bf16 v187, v21, v21
    v_dot2c_f32_bf16 v184, s73, v22
    v_dot2c_f32_bf16 v186, v22, v22
    v_dot2c_f32_bf16 v185, s73, v23
    v_dot2c_f32_bf16 v187, v23, v23
    v_dot2c_f32_bf16 v184, s73, v24
    v_dot2c_f32_bf16 v186, v24, v24
    v_dot2c_f32_bf16 v185, s73, v25
    v_dot2c_f32_bf16 v187, v25, v25
    v_dot2c_f32_bf16 v184, s73, v26
    v_dot2c_f32_bf16 v186, v26, v26
    v_dot2c_f32_bf16 v185, s73, v27
    v_dot2c_f32_bf16 v187, v27, v27
    v_dot2c_f32_bf16 v184, s73, v28
    v_dot2c_f32_bf16 v186, v28, v28
    v_dot2c_f32_bf16 v185, s73, v29
    v_dot2c_f32_bf16 v187, v29, v29
    v_dot2c_f32_bf16 v184, s73, v30
    v_dot2c_f32_bf16 v186, v30, v30
    v_dot2c_f32_bf16 v185, s73, v31
    v_dot2c_f32_bf16 v187, v31, v31
    ds_read_b128 v[32:35], v12 offset:16384
    ds_read_b128 v[36:39], v13 offset:16384
    ds_read_b128 v[40:43], v14 offset:16384
    ds_read_b128 v[44:47], v15 offset:16384
    s_lshl_b32 s60, s70, 7
    s_add_u32 s60, s60, s51
    s_add_u32 m0, s76, 65536
    s_nop 0
    buffer_load_dwordx4 v8, s[8:11], s60 offen lds
    s_add_u32 m0, s76, 66560
    s_nop 0
    buffer_load_dwordx4 v9, s[8:11], s60 offen lds
    v_and_b32 v4, 31, v1
    v_lshrrev_b32 v5, 5, v1
    v_lshlrev_b32 v5, 1, v5
    v_bfe_u32 v6, v1, 1, 3
    v_xor_b32 v5, v5, v6
    v_lshlrev_b32 v5, 3, v5
    v_lshl_add_u32 v243, v4, 6, v5
    s_lshl_b32 s60, s47, 11
    v_add_u32 v243, s60, v243
    s_waitcnt vmcnt(4)
    s_waitcnt lgkmcnt(0)
    s_barrier
    v_dot2c_f32_bf16 v184, s73, v32
    v_dot2c_f32_bf16 v186, v32, v32
    v_dot2c_f32_bf16 v185, s73, v33
    v_dot2c_f32_bf16 v187, v33, v33
    v_dot2c_f32_bf16 v184, s73, v34
    v_dot2c_f32_bf16 v186, v34, v34
    v_dot2c_f32_bf16 v185, s73, v35
    v_dot2c_f32_bf16 v187, v35, v35
    v_dot2c_f32_bf16 v184, s73, v36
    v_dot2c_f32_bf16 v186, v36, v36
    v_dot2c_f32_bf16 v185, s73, v37
    v_dot2c_f32_bf16 v187, v37, v37
    v_dot2c_f32_bf16 v184, s73, v38
    v_dot2c_f32_bf16 v186, v38, v38
    v_dot2c_f32_bf16 v185, s73, v39
    v_dot2c_f32_bf16 v187, v39, v39
    v_dot2c_f32_bf16 v184, s73, v40
    v_dot2c_f32_bf16 v186, v40, v40
    v_dot2c_f32_bf16 v185, s73, v41
    v_dot2c_f32_bf16 v187, v41, v41
    v_dot2c_f32_bf16 v184, s73, v42
    v_dot2c_f32_bf16 v186, v42, v42
    v_dot2c_f32_bf16 v185, s73, v43
    v_dot2c_f32_bf16 v187, v43, v43
    v_dot2c_f32_bf16 v184, s73, v44
    v_dot2c_f32_bf16 v186, v44, v44
    v_dot2c_f32_bf16 v185, s73, v45
    v_dot2c_f32_bf16 v187, v45, v45
    v_dot2c_f32_bf16 v184, s73, v46
    v_dot2c_f32_bf16 v186, v46, v46
    v_dot2c_f32_bf16 v185, s73, v47
    v_dot2c_f32_bf16 v187, v47, v47
    ds_read_b128 v[48:51], v12 offset:32768
    ds_read_b128 v[52:55], v13 offset:32768
    ds_read_b128 v[56:59], v14 offset:32768
    ds_read_b128 v[60:63], v15 offset:32768
    ds_read_u16 v200, v244
    ds_read_u16 v201, v244 offset:56
    s_lshl_b32 s60, s71, 7
    s_add_u32 s60, s60, s51
    s_add_u32 m0, s76, 81920
    s_nop 0
    buffer_load_dwordx4 v8, s[8:11], s60 offen lds
    s_add_u32 m0, s76, 82944
    s_nop 0
    buffer_load_dwordx4 v9, s[8:11], s60 offen lds
    s_waitcnt lgkmcnt(0)
    v_lshl_or_b32 v200, v201, 16, v200
    v_and_b32 v200, v200, v245
    ds_write_b32 v246, v200
    s_waitcnt vmcnt(4)
    s_waitcnt lgkmcnt(0)
    s_barrier
    v_dot2c_f32_bf16 v184, s73, v48
    v_dot2c_f32_bf16 v186, v48, v48
    v_dot2c_f32_bf16 v185, s73, v49
    v_dot2c_f32_bf16 v187, v49, v49
    v_dot2c_f32_bf16 v184, s73, v50
    v_dot2c_f32_bf16 v186, v50, v50
    v_dot2c_f32_bf16 v185, s73, v51
    v_dot2c_f32_bf16 v187, v51, v51
    v_dot2c_f32_bf16 v184, s73, v52
    v_dot2c_f32_bf16 v186, v52, v52
    v_dot2c_f32_bf16 v185, s73, v53
    v_dot2c_f32_bf16 v187, v53, v53
    v_dot2c_f32_bf16 v184, s73, v54
    v_dot2c_f32_bf16 v186, v54, v54
    v_dot2c_f32_bf16 v185, s73, v55
    v_dot2c_f32_bf16 v187, v55, v55
    v_dot2c_f32_bf16 v184, s73, v56
    v_dot2c_f32_bf16 v186, v56, v56
    v_dot2c_f32_bf16 v185, s73, v57
    v_dot2c_f32_bf16 v187, v57, v57
    v_dot2c_f32_bf16 v184, s73, v58
    v_dot2c_f32_bf16 v186, v58, v58
    v_dot2c_f32_bf16 v185, s73, v59
    v_dot2c_f32_bf16 v187, v59, v59
    v_dot2c_f32_bf16 v184, s73, v60
    v_dot2c_f32_bf16 v186, v60, v60
    v_dot2c_f32_bf16 v185, s73, v61
    v_dot2c_f32_bf16 v187, v61, v61
    v_dot2c_f32_bf16 v184, s73, v62
    v_dot2c_f32_bf16 v186, v62, v62
    v_dot2c_f32_bf16 v185, s73, v63
    v_dot2c_f32_bf16 v187, v63, v63
    ds_read_b128 v[64:67], v12 offset:49152
    ds_read_b128 v[68:71], v13 offset:49152
    ds_read_b128 v[72:75], v14 offset:49152
    ds_read_b128 v[76:79], v15 offset:49152
    s_lshl_b32 s60, s72, 7
    s_add_u32 s60, s60, s51
    s_add_u32 m0, s76, 98304
    s_nop 0
    buffer_load_dwordx4 v8, s[8:11], s60 offen lds
    s_add_u32 m0, s76, 99328
    s_nop 0
    buffer_load_dwordx4 v9, s[8:11], s60 offen lds
    v_add_u32 v12, 0x10000, v12
    v_add_u32 v13, 0x10000, v13
    v_add_u32 v14, 0x10000, v14
    v_add_u32 v15, 0x10000, v15
    s_waitcnt vmcnt(4)
    s_waitcnt lgkmcnt(0)
    s_barrier
    v_dot2c_f32_bf16 v184, s73, v64
    v_dot2c_f32_bf16 v186, v64, v64
    v_dot2c_f32_bf16 v185, s73, v65
    v_dot2c_f32_bf16 v187, v65, v65
    v_dot2c_f32_bf16 v184, s73, v66
    v_dot2c_f32_bf16 v186, v66, v66
    v_dot2c_f32_bf16 v185, s73, v67
    v_dot2c_f32_bf16 v187, v67, v67
    v_dot2c_f32_bf16 v184, s73, v68
    v_dot2c_f32_bf16 v186, v68, v68
    v_dot2c_f32_bf16 v185, s73, v69
    v_dot2c_f32_bf16 v187, v69, v69
    v_dot2c_f32_bf16 v184, s73, v70
    v_dot2c_f32_bf16 v186, v70, v70
    v_dot2c_f32_bf16 v185, s73, v71
    v_dot2c_f32_bf16 v187, v71, v71
    v_dot2c_f32_bf16 v184, s73, v72
    v_dot2c_f32_bf16 v186, v72, v72
    v_dot2c_f32_bf16 v185, s73, v73
    v_dot2c_f32_bf16 v187, v73, v73
    v_dot2c_f32_bf16 v184, s73, v74
    v_dot2c_f32_bf16 v186, v74, v74
    v_dot2c_f32_bf16 v185, s73, v75
    v_dot2c_f32_bf16 v187, v75, v75
    v_dot2c_f32_bf16 v184, s73, v76
    v_dot2c_f32_bf16 v186, v76, v76
    v_dot2c_f32_bf16 v185, s73, v77
    v_dot2c_f32_bf16 v187, v77, v77
    v_dot2c_f32_bf16 v184, s73, v78
    v_dot2c_f32_bf16 v186, v78, v78
    v_dot2c_f32_bf16 v185, s73, v79
    v_dot2c_f32_bf16 v187, v79, v79
    ds_read_b128 v[80:83], v12 offset:0
    ds_read_b128 v[84:87], v13 offset:0
    ds_read_b128 v[88:91], v14 offset:0
    ds_read_b128 v[92:95], v15 offset:0
    v_lshlrev_b32 v4, 4, v1
    v_add_u32 v4, 147456, v4
    ds_read_b128 v[176:179], v4
    ds_read_b128 v[180:183], v4 offset:1024
    s_mul_i32 s60, s66, 172032
    s_add_u32 s60, s60, s78
    s_add_u32 s60, s60, 1792
    s_add_u32 m0, s77, 28672
    s_nop 0
    buffer_load_dwordx4 v10, s[12:15], s60 offen lds
    s_mul_i32 s60, s67, 172032
    s_add_u32 s60, s60, s78
    s_add_u32 s60, s60, 1792
    s_add_u32 m0, s77, 32768
    s_nop 0
    buffer_load_dwordx4 v10, s[12:15], s60 offen lds
    s_waitcnt vmcnt(4)
    s_waitcnt lgkmcnt(0)
    s_barrier
    v_dot2c_f32_bf16 v184, s73, v80
    v_dot2c_f32_bf16 v186, v80, v80
    v_dot2c_f32_bf16 v185, s73, v81
    v_dot2c_f32_bf16 v187, v81, v81
    v_dot2c_f32_bf16 v184, s73, v82
    v_dot2c_f32_bf16 v186, v82, v82
    v_dot2c_f32_bf16 v185, s73, v83
    v_dot2c_f32_bf16 v187, v83, v83
    v_dot2c_f32_bf16 v184, s73, v84
    v_dot2c_f32_bf16 v186, v84, v84
    v_dot2c_f32_bf16 v185, s73, v85
    v_dot2c_f32_bf16 v187, v85, v85
    v_dot2c_f32_bf16 v184, s73, v86
    v_dot2c_f32_bf16 v186, v86, v86
    v_dot2c_f32_bf16 v185, s73, v87
    v_dot2c_f32_bf16 v187, v87, v87
    v_dot2c_f32_bf16 v184, s73, v88
    v_dot2c_f32_bf16 v186, v88, v88
    v_dot2c_f32_bf16 v185, s73, v89
    v_dot2c_f32_bf16 v187, v89, v89
    v_dot2c_f32_bf16 v184, s73, v90
    v_dot2c_f32_bf16 v186, v90, v90
    v_dot2c_f32_bf16 v185, s73, v91
    v_dot2c_f32_bf16 v187, v91, v91
    v_dot2c_f32_bf16 v184, s73, v92
    v_dot2c_f32_bf16 v186, v92, v92
    v_dot2c_f32_bf16 v185, s73, v93
    v_dot2c_f32_bf16 v187, v93, v93
    v_dot2c_f32_bf16 v184, s73, v94
    v_dot2c_f32_bf16 v186, v94, v94
    v_dot2c_f32_bf16 v185, s73, v95
    v_dot2c_f32_bf16 v187, v95, v95
    ds_read_b128 v[96:99], v12 offset:16384
    ds_read_b128 v[100:103], v13 offset:16384
    ds_read_b128 v[104:107], v14 offset:16384
    ds_read_b128 v[108:111], v15 offset:16384
    s_mul_i32 s60, s68, 172032
    s_add_u32 s60, s60, s78
    s_add_u32 s60, s60, 1792
    s_add_u32 m0, s77, 36864
    s_nop 0
    buffer_load_dwordx4 v10, s[12:15], s60 offen lds
    s_mul_i32 s60, s69, 172032
    s_add_u32 s60, s60, s78
    s_add_u32 s60, s60, 1792
    s_add_u32 m0, s77, 40960
    s_nop 0
    buffer_load_dwordx4 v10, s[12:15], s60 offen lds
    s_setprio 2
    s_waitcnt lgkmcnt(3)
    v_dot2c_f32_bf16 v184, s73, v96
    v_dot2c_f32_bf16 v186, v96, v96
    v_dot2c_f32_bf16 v185, s73, v97
    v_dot2c_f32_bf16 v187, v97, v97
    v_dot2c_f32_bf16 v184, s73, v98
    v_dot2c_f32_bf16 v186, v98, v98
    v_dot2c_f32_bf16 v185, s73, v99
    v_dot2c_f32_bf16 v187, v99, v99
    s_waitcnt lgkmcnt(2)
    v_dot2c_f32_bf16 v184, s73, v100
    v_dot2c_f32_bf16 v186, v100, v100
    v_dot2c_f32_bf16 v185, s73, v101
    v_dot2c_f32_bf16 v187, v101, v101
    v_dot2c_f32_bf16 v184, s73, v102
    v_dot2c_f32_bf16 v186, v102, v102
    v_dot2c_f32_bf16 v185, s73, v103
    v_dot2c_f32_bf16 v187, v103, v103
    s_waitcnt lgkmcnt(1)
    v_dot2c_f32_bf16 v184, s73, v104
    v_dot2c_f32_bf16 v186, v104, v104
    v_dot2c_f32_bf16 v185, s73, v105
    v_dot2c_f32_bf16 v187, v105, v105
    v_dot2c_f32_bf16 v184, s73, v106
    v_dot2c_f32_bf16 v186, v106, v106
    v_dot2c_f32_bf16 v185, s73, v107
    v_dot2c_f32_bf16 v187, v107, v107
    s_waitcnt lgkmcnt(0)
    v_dot2c_f32_bf16 v184, s73, v108
    v_dot2c_f32_bf16 v186, v108, v108
    v_dot2c_f32_bf16 v185, s73, v109
    v_dot2c_f32_bf16 v187, v109, v109
    v_dot2c_f32_bf16 v184, s73, v110
    v_dot2c_f32_bf16 v186, v110, v110
    v_dot2c_f32_bf16 v185, s73, v111
    v_dot2c_f32_bf16 v187, v111, v111
    s_waitcnt vmcnt(4)
    s_waitcnt lgkmcnt(0)
    s_barrier
    ds_read_b128 v[112:115], v12 offset:32768
    ds_read_b128 v[116:119], v13 offset:32768
    ds_read_b128 v[120:123], v14 offset:32768
    ds_read_b128 v[124:127], v15 offset:32768
    s_waitcnt lgkmcnt(3)
    v_dot2c_f32_bf16 v184, s73, v112
    v_dot2c_f32_bf16 v186, v112, v112
    v_dot2c_f32_bf16 v185, s73, v113
    v_dot2c_f32_bf16 v187, v113, v113
    v_dot2c_f32_bf16 v184, s73, v114
    v_dot2c_f32_bf16 v186, v114, v114
    v_dot2c_f32_bf16 v185, s73, v115
    v_dot2c_f32_bf16 v187, v115, v115
    s_waitcnt lgkmcnt(2)
    v_dot2c_f32_bf16 v184, s73, v116
    v_dot2c_f32_bf16 v186, v116, v116
    v_dot2c_f32_bf16 v185, s73, v117
    v_dot2c_f32_bf16 v187, v117, v117
    v_dot2c_f32_bf16 v184, s73, v118
    v_dot2c_f32_bf16 v186, v118, v118
    v_dot2c_f32_bf16 v185, s73, v119
    v_dot2c_f32_bf16 v187, v119, v119
    s_waitcnt lgkmcnt(1)
    v_dot2c_f32_bf16 v184, s73, v120
    v_dot2c_f32_bf16 v186, v120, v120
    v_dot2c_f32_bf16 v185, s73, v121
    v_dot2c_f32_bf16 v187, v121, v121
    v_dot2c_f32_bf16 v184, s73, v122
    v_dot2c_f32_bf16 v186, v122, v122
    v_dot2c_f32_bf16 v185, s73, v123
    v_dot2c_f32_bf16 v187, v123, v123
    s_waitcnt lgkmcnt(0)
    v_dot2c_f32_bf16 v184, s73, v124
    v_dot2c_f32_bf16 v186, v124, v124
    v_dot2c_f32_bf16 v185, s73, v125
    v_dot2c_f32_bf16 v187, v125, v125
    v_dot2c_f32_bf16 v184, s73, v126
    v_dot2c_f32_bf16 v186, v126, v126
    v_dot2c_f32_bf16 v185, s73, v127
    v_dot2c_f32_bf16 v187, v127, v127
    s_nop 1
    v_add_f32 v184, v184, v185
    v_add_f32 v186, v186, v187
    v_mov_b32 v185, v184
    v_mov_b32 v187, v186
    s_nop 0
    v_permlane32_swap_b32 v184, v185
    v_permlane32_swap_b32 v186, v187
    v_add_f32 v184, v184, v185
    v_add_f32 v186, v186, v187
    v_mul_f32 v184, 0xbb124925, v184
    v_mul_f32 v186, 0x3b124925, v186
    v_fma_f32 v186, -v184, v184, v186
    v_max_f32 v186, 0, v186
    v_add_f32 v186, 0x3727c5ac, v186
    v_rsq_f32 v190, v186
    v_cvt_pk_bf16_f32 v185, 0, v184
    v_sub_f32 v187, v184, v185
    v_cvt_pk_bf16_f32 v188, v185, v187
    v_cvt_pk_bf16_f32 v189, v185, 0
    ds_write_b128 v247, v[188:191]
    v_mov_b32 v192, v190
    v_mul_f32 v194, 0x3fb8aa3b, v190
    s_waitcnt vmcnt(2)
    s_waitcnt lgkmcnt(0)
    s_barrier
    s_setprio 2
    ds_read_b64_tr_b16 v[144:145], v248 offset:28672
    ds_read_b64_tr_b16 v[146:147], v248 offset:28928
    ds_read_b64_tr_b16 v[148:149], v249 offset:28672
    ds_read_b64_tr_b16 v[150:151], v249 offset:28928
    ds_read_b64_tr_b16 v[152:153], v250 offset:28672
    ds_read_b64_tr_b16 v[154:155], v250 offset:28928
    ds_read_b64_tr_b16 v[156:157], v251 offset:28672
    ds_read_b64_tr_b16 v[158:159], v251 offset:28928
    v_mov_b32 v190, 0
    s_mul_i32 s60, s70, 172032
    s_add_u32 s60, s60, s78
    s_add_u32 s60, s60, 1792
    s_add_u32 m0, s77, 45056
    s_nop 0
    buffer_load_dwordx4 v10, s[12:15], s60 offen lds
    s_mul_i32 s60, s71, 172032
    s_add_u32 s60, s60, s78
    s_add_u32 s60, s60, 1792
    s_add_u32 m0, s77, 49152
    s_nop 0
    buffer_load_dwordx4 v10, s[12:15], s60 offen lds
    v_xor_b32 v12, 0, v243
    v_xor_b32 v13, 8, v243
    v_xor_b32 v14, 32, v243
    v_xor_b32 v15, 40, v243
    s_waitcnt lgkmcnt(6)
    v_dot2c_f32_bf16 v193, s73, v144
    v_dot2c_f32_bf16 v193, s73, v145
    v_dot2c_f32_bf16 v193, s73, v146
    v_dot2c_f32_bf16 v193, s73, v147
    v_mfma_f32_32x32x16_bf16 v[128:143], v[144:147], v[16:19], 0
    ds_read_b64_tr_b16 v[160:161], v248 offset:32768
    ds_read_b64_tr_b16 v[162:163], v248 offset:33024
    s_waitcnt lgkmcnt(6)
    v_mfma_f32_32x32x16_bf16 v[128:143], v[148:151], v[20:23], v[128:143]
    ds_read_b64_tr_b16 v[164:165], v249 offset:32768
    ds_read_b64_tr_b16 v[166:167], v249 offset:33024
    s_waitcnt lgkmcnt(6)
    v_mfma_f32_32x32x16_bf16 v[128:143], v[152:155], v[24:27], v[128:143]
    ds_read_b64_tr_b16 v[168:169], v250 offset:32768
    ds_read_b64_tr_b16 v[170:171], v250 offset:33024
    s_waitcnt lgkmcnt(6)
    v_mfma_f32_32x32x16_bf16 v[128:143], v[156:159], v[28:31], v[128:143]
    ds_read_b64_tr_b16 v[172:173], v251 offset:32768
    ds_read_b64_tr_b16 v[174:175], v251 offset:33024
    s_waitcnt lgkmcnt(6)
    v_dot2c_f32_bf16 v193, s73, v160
    v_dot2c_f32_bf16 v193, s73, v161
    v_dot2c_f32_bf16 v193, s73, v162
    v_dot2c_f32_bf16 v193, s73, v163
    s_waitcnt vmcnt(2)
    s_waitcnt lgkmcnt(0)
    s_mov_b64 exec, 1
    ds_add_u32 v2, v3 offset:132
    s_mov_b64 exec, -1
    s_mul_i32 s60, s72, 172032
    s_add_u32 s60, s60, s78
    s_add_u32 s60, s60, 1792
    s_add_u32 m0, s77, 53248
    s_nop 0
    buffer_load_dwordx4 v10, s[12:15], s60 offen lds
    s_cmp_eq_u32 s7, 0
    s_cbranch_scc0 var_112
    v_lshlrev_b32 v4, 7, v1
    s_cmp_gt_u32 s47, 0
    s_cbranch_scc1 tch_114
    buffer_load_dword v255, v4, s[40:43], s6 offen sc1
    s_branch tch_113
tch_114:
    s_cmp_gt_u32 s47, 2
    s_cbranch_scc1 tch_115
    buffer_load_dword v255, v4, s[24:27], s6 offen
    s_branch tch_113
tch_115:
    buffer_load_dword v255, v4, s[32:35], s6 offen
tch_116:
tch_113:
var_112:
    s_mov_b32 s59, 0
cw_117:
    ds_read_b32 v4, v2 offset:132
    s_add_u32 s59, s59, 1
    s_lshr_b32 s3, s59, 20
    s_waitcnt lgkmcnt(0)
    v_readfirstlane_b32 s60, v4
    s_nop 0
    s_max_u32 s60, s60, s3
    s_cmp_lt_u32 s60, 4
    s_cbranch_scc1 cw_117
    v_mfma_f32_32x32x16_bf16 v[128:143], v[160:163], v[32:35], v[128:143]
    ds_read_b64_tr_b16 v[144:145], v248 offset:36864
    ds_read_b64_tr_b16 v[146:147], v248 offset:37120
    v_mfma_f32_32x32x16_bf16 v[128:143], v[164:167], v[36:39], v[128:143]
    ds_read_b64_tr_b16 v[148:149], v249 offset:36864
    ds_read_b64_tr_b16 v[150:151], v249 offset:37120
    v_mfma_f32_32x32x16_bf16 v[128:143], v[168:171], v[40:43], v[128:143]
    ds_read_b64_tr_b16 v[152:153], v250 offset:36864
    ds_read_b64_tr_b16 v[154:155], v250 offset:37120
    v_mfma_f32_32x32x16_bf16 v[128:143], v[172:175], v[44:47], v[128:143]
    ds_read_b64_tr_b16 v[156:157], v251 offset:36864
    ds_read_b64_tr_b16 v[158:159], v251 offset:37120
    s_waitcnt lgkmcnt(6)
    v_dot2c_f32_bf16 v193, s73, v144
    v_dot2c_f32_bf16 v193, s73, v145
    v_dot2c_f32_bf16 v193, s73, v146
    v_dot2c_f32_bf16 v193, s73, v147
    v_mfma_f32_32x32x16_bf16 v[128:143], v[144:147], v[48:51], v[128:143]
    ds_read_b64_tr_b16 v[160:161], v248 offset:40960
    ds_read_b64_tr_b16 v[162:163], v248 offset:41216
    s_waitcnt lgkmcnt(6)
    v_mfma_f32_32x32x16_bf16 v[128:143], v[148:151], v[52:55], v[128:143]
    ds_read_b64_tr_b16 v[164:165], v249 offset:40960
    ds_read_b64_tr_b16 v[166:167], v249 offset:41216
    s_waitcnt lgkmcnt(6)
    v_mfma_f32_32x32x16_bf16 v[128:143], v[152:155], v[56:59], v[128:143]
    ds_read_b64_tr_b16 v[168:169], v250 offset:40960
    ds_read_b64_tr_b16 v[170:171], v250 offset:41216
    s_waitcnt lgkmcnt(6)
    v_mfma_f32_32x32x16_bf16 v[128:143], v[156:159], v[60:63], v[128:143]
    ds_read_b64_tr_b16 v[172:173], v251 offset:40960
    ds_read_b64_tr_b16 v[174:175], v251 offset:41216
    s_waitcnt lgkmcnt(6)
    v_dot2c_f32_bf16 v193, s73, v160
    v_dot2c_f32_bf16 v193, s73, v161
    v_dot2c_f32_bf16 v193, s73, v162
    v_dot2c_f32_bf16 v193, s73, v163
    s_waitcnt vmcnt(2)
    s_cmp_eq_u32 s7, 0
    s_cbranch_scc1 var_118
    s_waitcnt vmcnt(1)
var_118:
    s_waitcnt lgkmcnt(0)
    s_mov_b64 exec, 1
    ds_add_u32 v2, v3 offset:136
    s_mov_b64 exec, -1
    s_mov_b32 s59, 0
cw_119:
    ds_read_b32 v4, v2 offset:136
    s_add_u32 s59, s59, 1
    s_lshr_b32 s3, s59, 20
    s_waitcnt lgkmcnt(0)
    v_readfirstlane_b32 s60, v4
    s_nop 0
    s_max_u32 s60, s60, s3
    s_cmp_lt_u32 s60, 4
    s_cbranch_scc1 cw_119
    v_mfma_f32_32x32x16_bf16 v[128:143], v[160:163], v[64:67], v[128:143]
    ds_read_b64_tr_b16 v[144:145], v248 offset:45056
    ds_read_b64_tr_b16 v[146:147], v248 offset:45312
    v_mfma_f32_32x32x16_bf16 v[128:143], v[164:167], v[68:71], v[128:143]
    ds_read_b64_tr_b16 v[148:149], v249 offset:45056
    ds_read_b64_tr_b16 v[150:151], v249 offset:45312
    v_mfma_f32_32x32x16_bf16 v[128:143], v[168:171], v[72:75], v[128:143]
    ds_read_b64_tr_b16 v[152:153], v250 offset:45056
    ds_read_b64_tr_b16 v[154:155], v250 offset:45312
    v_mfma_f32_32x32x16_bf16 v[128:143], v[172:175], v[76:79], v[128:143]
    ds_read_b64_tr_b16 v[156:157], v251 offset:45056
    ds_read_b64_tr_b16 v[158:159], v251 offset:45312
    s_waitcnt lgkmcnt(6)
    v_dot2c_f32_bf16 v193, s73, v144
    v_dot2c_f32_bf16 v193, s73, v145
    v_dot2c_f32_bf16 v193, s73, v146
    v_dot2c_f32_bf16 v193, s73, v147
    v_mfma_f32_32x32x16_bf16 v[128:143], v[144:147], v[80:83], v[128:143]
    ds_read_b64_tr_b16 v[160:161], v248 offset:49152
    ds_read_b64_tr_b16 v[162:163], v248 offset:49408
    s_waitcnt lgkmcnt(6)
    v_mfma_f32_32x32x16_bf16 v[128:143], v[148:151], v[84:87], v[128:143]
    ds_read_b64_tr_b16 v[164:165], v249 offset:49152
    ds_read_b64_tr_b16 v[166:167], v249 offset:49408
    s_waitcnt lgkmcnt(6)
    v_mfma_f32_32x32x16_bf16 v[128:143], v[152:155], v[88:91], v[128:143]
    ds_read_b64_tr_b16 v[168:169], v250 offset:49152
    ds_read_b64_tr_b16 v[170:171], v250 offset:49408
    s_waitcnt lgkmcnt(6)
    v_mfma_f32_32x32x16_bf16 v[128:143], v[156:159], v[92:95], v[128:143]
    ds_read_b64_tr_b16 v[172:173], v251 offset:49152
    ds_read_b64_tr_b16 v[174:175], v251 offset:49408
    s_waitcnt lgkmcnt(6)
    v_dot2c_f32_bf16 v193, s73, v160
    v_dot2c_f32_bf16 v193, s73, v161
    v_dot2c_f32_bf16 v193, s73, v162
    v_dot2c_f32_bf16 v193, s73, v163
    s_nop 2
    ds_write_b32 v252, v193
    s_waitcnt vmcnt(1)
    s_cmp_eq_u32 s7, 0
    s_cbranch_scc1 var_120
    s_waitcnt vmcnt(0)
var_120:
    s_waitcnt lgkmcnt(0)
    s_mov_b64 exec, 1
    ds_add_u32 v2, v3 offset:140
    s_mov_b64 exec, -1
    s_mov_b32 s59, 0
cw_121:
    ds_read_b32 v4, v2 offset:140
    s_add_u32 s59, s59, 1
    s_lshr_b32 s3, s59, 20
    s_waitcnt lgkmcnt(0)
    v_readfirstlane_b32 s60, v4
    s_nop 0
    s_max_u32 s60, s60, s3
    s_cmp_lt_u32 s60, 4
    s_cbranch_scc1 cw_121
    ds_read_b128 v[200:203], v253
    v_mfma_f32_32x32x16_bf16 v[128:143], v[160:163], v[96:99], v[128:143]
    ds_read_b64_tr_b16 v[144:145], v248 offset:53248
    ds_read_b64_tr_b16 v[146:147], v248 offset:53504
    v_mfma_f32_32x32x16_bf16 v[128:143], v[164:167], v[100:103], v[128:143]
    ds_read_b64_tr_b16 v[148:149], v249 offset:53248
    ds_read_b64_tr_b16 v[150:151], v249 offset:53504
    v_mfma_f32_32x32x16_bf16 v[128:143], v[168:171], v[104:107], v[128:143]
    ds_read_b64_tr_b16 v[152:153], v250 offset:53248
    ds_read_b64_tr_b16 v[154:155], v250 offset:53504
    v_mfma_f32_32x32x16_bf16 v[128:143], v[172:175], v[108:111], v[128:143]
    ds_read_b64_tr_b16 v[156:157], v251 offset:53248
    ds_read_b64_tr_b16 v[158:159], v251 offset:53504
    s_waitcnt lgkmcnt(6)
    v_dot2c_f32_bf16 v195, s73, v144
    v_dot2c_f32_bf16 v195, s73, v145
    v_dot2c_f32_bf16 v195, s73, v146
    v_dot2c_f32_bf16 v195, s73, v147
    s_waitcnt lgkmcnt(4)
    v_dot2c_f32_bf16 v195, s73, v148
    v_dot2c_f32_bf16 v195, s73, v149
    v_dot2c_f32_bf16 v195, s73, v150
    v_dot2c_f32_bf16 v195, s73, v151
    s_waitcnt lgkmcnt(2)
    v_dot2c_f32_bf16 v195, s73, v152
    v_dot2c_f32_bf16 v195, s73, v153
    v_dot2c_f32_bf16 v195, s73, v154
    v_dot2c_f32_bf16 v195, s73, v155
    s_waitcnt lgkmcnt(0)
    v_dot2c_f32_bf16 v195, s73, v156
    v_dot2c_f32_bf16 v195, s73, v157
    v_dot2c_f32_bf16 v195, s73, v158
    v_dot2c_f32_bf16 v195, s73, v159
    v_mfma_f32_32x32x16_bf16 v[128:143], v[144:147], v[112:115], v[128:143]
    v_add_f32 v200, v200, v201
    v_add_f32 v202, v202, v203
    v_add_f32 v195, v195, v200
    v_add_f32 v195, v195, v202
    v_cvt_pk_bf16_f32 v200, 0, v195
    v_sub_f32 v201, v195, v200
    v_cvt_pk_bf16_f32 v196, v200, v200
    v_cvt_pk_bf16_f32 v197, v201, 0
    v_mfma_f32_32x32x16_bf16 v[128:143], v[148:151], v[116:119], v[128:143]
    v_mfma_f32_32x32x16_bf16 v[128:143], v[152:155], v[120:123], v[128:143]
    v_mfma_f32_32x32x16_bf16 v[128:143], v[156:159], v[124:127], v[128:143]
    v_mfma_f32_32x32x16_bf16 v[128:143], v[196:199], v[188:191], v[128:143]
    v_mov_b32 v193, 0
    v_mov_b32 v195, 0
    v_add_u32 v248, 61440, v248
    v_add_u32 v249, 61440, v249
    v_add_u32 v250, 61440, v250
    v_add_u32 v251, 61440, v251
    s_nop 5
    v_pk_mul_f32 v[128:129], v[128:129], v[192:193] op_sel_hi:[1,0]
    v_pk_mul_f32 v[130:131], v[130:131], v[192:193] op_sel_hi:[1,0]
    v_pk_mul_f32 v[132:133], v[132:133], v[192:193] op_sel_hi:[1,0]
    v_pk_mul_f32 v[134:135], v[134:135], v[192:193] op_sel_hi:[1,0]
    v_pk_mul_f32 v[136:137], v[136:137], v[192:193] op_sel_hi:[1,0]
    v_pk_mul_f32 v[138:139], v[138:139], v[192:193] op_sel_hi:[1,0]
    v_pk_mul_f32 v[140:141], v[140:141], v[192:193] op_sel_hi:[1,0]
    v_pk_mul_f32 v[142:143], v[142:143], v[192:193] op_sel_hi:[1,0]
    s_mov_b32 exec_hi, 0
    v_cvt_pk_bf16_f32 v204, v128, v129
    v_cvt_pk_bf16_f32 v205, v130, v131
    v_cvt_pk_bf16_f32 v206, v132, v133
    v_cvt_pk_bf16_f32 v207, v134, v135
    v_cvt_pk_bf16_f32 v208, v136, v137
    v_cvt_pk_bf16_f32 v209, v138, v139
    v_cvt_pk_bf16_f32 v210, v140, v141
    v_cvt_pk_bf16_f32 v211, v142, v143
    s_mov_b32 exec_hi, -1
    s_mov_b32 exec_lo, 0
    v_cvt_pk_bf16_f32 v204, v128, v129
    v_cvt_pk_bf16_f32 v205, v130, 1.0
    v_cvt_pk_bf16_f32 v206, v131, v132
    v_cvt_pk_bf16_f32 v207, v133, 1.0
    v_cvt_pk_bf16_f32 v208, v134, v135
    v_cvt_pk_bf16_f32 v209, v136, 1.0
    v_cvt_pk_bf16_f32 v210, v137, v138
    v_cvt_pk_bf16_f32 v211, v139, 1.0
    s_mov_b32 exec_lo, -1
    ds_write_b64 v12, v[204:205] offset:16384
    ds_write_b64 v13, v[206:207] offset:16384
    ds_write_b64 v14, v[208:209] offset:16384
    ds_write_b64 v15, v[210:211] offset:16384
    s_waitcnt lgkmcnt(0)
    s_barrier
    v_readfirstlane_b32 s48, v254
    s_nop 0
    s_lshr_b32 s63, s48, 16
    s_mul_i32 s48, s48, 1664525
    s_add_u32 s48, s48, 1013904223
    s_and_b32 s49, s48, 0x1fff
    s_or_b32 s49, s49, 0x2000
    s_bfe_u32 s64, s48, 0x1000d
    s_lshl_b32 s64, s64, 15
    s_or_b32 s49, s49, s64
    s_cmp_lg_u32 s49, s63
    s_cbranch_scc1 mt_123
    s_mul_i32 s48, s48, 1664525
    s_add_u32 s48, s48, 1013904223
    s_and_b32 s49, s48, 0x1fff
    s_or_b32 s49, s49, 0x2000
    s_bfe_u32 s64, s48, 0x1000d
    s_lshl_b32 s64, s64, 15
    s_or_b32 s49, s49, s64
mt_123:
    s_lshl_b32 s50, s49, 16
    v_bfe_u32 v12, v1, 4, 1
    v_mul_u32_u24 v12, 16384, v12
    v_lshrrev_b32 v5, 5, v1
    v_lshl_add_u32 v12, v5, 8, v12
    v_and_b32 v5, 15, v1
    v_lshl_add_u32 v12, v5, 4, v12
    s_lshl_b32 s62, s5, 2
    s_add_u32 s62, s62, s47
    s_lshl_b32 s62, s62, 15
    s_lshl_b32 s63, s46, 10
    s_add_u32 s62, s62, s63
    s_add_u32 s62, s62, 2097152
    v_mov_b32 v8, s50
    v_lshlrev_b32 v13, 4, v1
    v_add_u32 v13, 157696, v13
    s_setprio 1
    s_mov_b32 s59, 0
cw_124:
    ds_read_b32 v4, v2 offset:24
    s_add_u32 s59, s59, 1
    s_lshr_b32 s3, s59, 20
    s_waitcnt lgkmcnt(0)
    v_readfirstlane_b32 s60, v4
    s_nop 0
    s_max_u32 s60, s60, s3
    s_cmp_lt_u32 s60, 4
    s_cbranch_scc1 cw_124
    ds_read_b64_tr_b16 v[144:145], v248 offset:0
    ds_read_b64_tr_b16 v[146:147], v248 offset:256
    ds_read_b64_tr_b16 v[148:149], v249 offset:0
    ds_read_b64_tr_b16 v[150:151], v249 offset:256
    ds_read_b64_tr_b16 v[152:153], v250 offset:0
    ds_read_b64_tr_b16 v[154:155], v250 offset:256
    ds_read_b64_tr_b16 v[156:157], v251 offset:0
    ds_read_b64_tr_b16 v[158:159], v251 offset:256
    s_waitcnt lgkmcnt(6)
    v_dot2c_f32_bf16 v193, s73, v144
    v_dot2c_f32_bf16 v193, s73, v145
    v_dot2c_f32_bf16 v193, s73, v146
    v_dot2c_f32_bf16 v193, s73, v147
    v_mfma_f32_32x32x16_bf16 v[128:143], v[144:147], v[16:19], 0
    ds_read_b64_tr_b16 v[160:161], v248 offset:4096
    ds_read_b64_tr_b16 v[162:163], v248 offset:4352
    s_waitcnt lgkmcnt(6)
    v_mfma_f32_32x32x16_bf16 v[128:143], v[148:151], v[20:23], v[128:143]
    ds_read_b64_tr_b16 v[164:165], v249 offset:4096
    ds_read_b64_tr_b16 v[166:167], v249 offset:4352
    s_waitcnt lgkmcnt(6)
    v_mfma_f32_32x32x16_bf16 v[128:143], v[152:155], v[24:27], v[128:143]
    ds_read_b64_tr_b16 v[168:169], v250 offset:4096
    ds_read_b64_tr_b16 v[170:171], v250 offset:4352
    s_waitcnt lgkmcnt(6)
    v_mfma_f32_32x32x16_bf16 v[128:143], v[156:159], v[28:31], v[128:143]
    ds_read_b64_tr_b16 v[172:173], v251 offset:4096
    ds_read_b64_tr_b16 v[174:175], v251 offset:4352
    s_waitcnt lgkmcnt(6)
    v_dot2c_f32_bf16 v193, s73, v160
    v_dot2c_f32_bf16 v193, s73, v161
    v_dot2c_f32_bf16 v193, s73, v162
    v_dot2c_f32_bf16 v193, s73, v163
    v_mfma_f32_32x32x16_bf16 v[128:143], v[160:163], v[32:35], v[128:143]
    ds_read_b64_tr_b16 v[144:145], v248 offset:8192
    ds_read_b64_tr_b16 v[146:147], v248 offset:8448
    s_waitcnt lgkmcnt(6)
    v_mfma_f32_32x32x16_bf16 v[128:143], v[164:167], v[36:39], v[128:143]
    ds_read_b64_tr_b16 v[148:149], v249 offset:8192
    ds_read_b64_tr_b16 v[150:151], v249 offset:8448
    s_waitcnt lgkmcnt(6)
    v_mfma_f32_32x32x16_bf16 v[128:143], v[168:171], v[40:43], v[128:143]
    ds_read_b64_tr_b16 v[152:153], v250 offset:8192
    ds_read_b64_tr_b16 v[154:155], v250 offset:8448
    s_waitcnt lgkmcnt(6)
    v_mfma_f32_32x32x16_bf16 v[128:143], v[172:175], v[44:47], v[128:143]
    ds_read_b64_tr_b16 v[156:157], v251 offset:8192
    ds_read_b64_tr_b16 v[158:159], v251 offset:8448
    s_waitcnt lgkmcnt(6)
    v_dot2c_f32_bf16 v193, s73, v144
    v_dot2c_f32_bf16 v193, s73, v145
    v_dot2c_f32_bf16 v193, s73, v146
    v_dot2c_f32_bf16 v193, s73, v147
    v_mfma_f32_32x32x16_bf16 v[128:143], v[144:147], v[48:51], v[128:143]
    ds_read_b64_tr_b16 v[160:161], v248 offset:12288
    ds_read_b64_tr_b16 v[162:163], v248 offset:12544
    s_waitcnt lgkmcnt(6)
    v_mfma_f32_32x32x16_bf16 v[128:143], v[148:151], v[52:55], v[128:143]
    ds_read_b64_tr_b16 v[164:165], v249 offset:12288
    ds_read_b64_tr_b16 v[166:167], v249 offset:12544
    s_waitcnt lgkmcnt(6)
    v_mfma_f32_32x32x16_bf16 v[128:143], v[152:155], v[56:59], v[128:143]
    ds_read_b64_tr_b16 v[168:169], v250 offset:12288
    ds_read_b64_tr_b16 v[170:171], v250 offset:12544
    s_waitcnt lgkmcnt(6)
    v_mfma_f32_32x32x16_bf16 v[128:143], v[156:159], v[60:63], v[128:143]
    ds_read_b64_tr_b16 v[172:173], v251 offset:12288
    ds_read_b64_tr_b16 v[174:175], v251 offset:12544
    s_waitcnt lgkmcnt(6)
    v_dot2c_f32_bf16 v193, s73, v160
    v_dot2c_f32_bf16 v193, s73, v161
    v_dot2c_f32_bf16 v193, s73, v162
    v_dot2c_f32_bf16 v193, s73, v163
    s_mov_b32 s59, 0
cw_125:
    ds_read_b32 v4, v2 offset:28
    s_add_u32 s59, s59, 1
    s_lshr_b32 s3, s59, 20
    s_waitcnt lgkmcnt(0)
    v_readfirstlane_b32 s60, v4
    s_nop 0
    s_max_u32 s60, s60, s3
    s_cmp_lt_u32 s60, 4
    s_cbranch_scc1 cw_125
    v_mfma_f32_32x32x16_bf16 v[128:143], v[160:163], v[64:67], v[128:143]
    ds_read_b64_tr_b16 v[144:145], v248 offset:16384
    ds_read_b64_tr_b16 v[146:147], v248 offset:16640
    v_mfma_f32_32x32x16_bf16 v[128:143], v[164:167], v[68:71], v[128:143]
    ds_read_b64_tr_b16 v[148:149], v249 offset:16384
    ds_read_b64_tr_b16 v[150:151], v249 offset:16640
    v_mfma_f32_32x32x16_bf16 v[128:143], v[168:171], v[72:75], v[128:143]
    ds_read_b64_tr_b16 v[152:153], v250 offset:16384
    ds_read_b64_tr_b16 v[154:155], v250 offset:16640
    v_mfma_f32_32x32x16_bf16 v[128:143], v[172:175], v[76:79], v[128:143]
    ds_read_b64_tr_b16 v[156:157], v251 offset:16384
    ds_read_b64_tr_b16 v[158:159], v251 offset:16640
    s_waitcnt lgkmcnt(6)
    v_dot2c_f32_bf16 v193, s73, v144
    v_dot2c_f32_bf16 v193, s73, v145
    v_dot2c_f32_bf16 v193, s73, v146
    v_dot2c_f32_bf16 v193, s73, v147
    v_mfma_f32_32x32x16_bf16 v[128:143], v[144:147], v[80:83], v[128:143]
    ds_read_b64_tr_b16 v[160:161], v248 offset:20480
    ds_read_b64_tr_b16 v[162:163], v248 offset:20736
    s_waitcnt lgkmcnt(6)
    v_mfma_f32_32x32x16_bf16 v[128:143], v[148:151], v[84:87], v[128:143]
    ds_read_b64_tr_b16 v[164:165], v249 offset:20480
    ds_read_b64_tr_b16 v[166:167], v249 offset:20736
    s_waitcnt lgkmcnt(6)
    v_mfma_f32_32x32x16_bf16 v[128:143], v[152:155], v[88:91], v[128:143]
    ds_read_b64_tr_b16 v[168:169], v250 offset:20480
    ds_read_b64_tr_b16 v[170:171], v250 offset:20736
    s_waitcnt lgkmcnt(6)
    v_mfma_f32_32x32x16_bf16 v[128:143], v[156:159], v[92:95], v[128:143]
    ds_read_b64_tr_b16 v[172:173], v251 offset:20480
    ds_read_b64_tr_b16 v[174:175], v251 offset:20736
    s_waitcnt lgkmcnt(6)
    v_dot2c_f32_bf16 v193, s73, v160
    v_dot2c_f32_bf16 v193, s73, v161
    v_dot2c_f32_bf16 v193, s73, v162
    v_dot2c_f32_bf16 v193, s73, v163
    s_nop 2
    ds_write_b32 v252, v193
    s_waitcnt lgkmcnt(0)
    s_mov_b64 exec, 1
    ds_add_u32 v2, v3 offset:32
    s_mov_b64 exec, -1
    s_mov_b32 s59, 0
cw_126:
    ds_read_b32 v4, v2 offset:32
    s_add_u32 s59, s59, 1
    s_lshr_b32 s3, s59, 20
    s_waitcnt lgkmcnt(0)
    v_readfirstlane_b32 s60, v4
    s_nop 0
    s_max_u32 s60, s60, s3
    s_cmp_lt_u32 s60, 8
    s_cbranch_scc1 cw_126
    ds_read_b128 v[200:203], v253
    v_mfma_f32_32x32x16_bf16 v[128:143], v[160:163], v[96:99], v[128:143]
    ds_read_b64_tr_b16 v[144:145], v248 offset:24576
    ds_read_b64_tr_b16 v[146:147], v248 offset:24832
    v_mfma_f32_32x32x16_bf16 v[128:143], v[164:167], v[100:103], v[128:143]
    ds_read_b64_tr_b16 v[148:149], v249 offset:24576
    ds_read_b64_tr_b16 v[150:151], v249 offset:24832
    v_mfma_f32_32x32x16_bf16 v[128:143], v[168:171], v[104:107], v[128:143]
    ds_read_b64_tr_b16 v[152:153], v250 offset:24576
    ds_read_b64_tr_b16 v[154:155], v250 offset:24832
    v_mfma_f32_32x32x16_bf16 v[128:143], v[172:175], v[108:111], v[128:143]
    ds_read_b64_tr_b16 v[156:157], v251 offset:24576
    ds_read_b64_tr_b16 v[158:159], v251 offset:24832
    s_waitcnt lgkmcnt(6)
    v_dot2c_f32_bf16 v195, s73, v144
    v_dot2c_f32_bf16 v195, s73, v145
    v_dot2c_f32_bf16 v195, s73, v146
    v_dot2c_f32_bf16 v195, s73, v147
    s_waitcnt lgkmcnt(4)
    v_dot2c_f32_bf16 v195, s73, v148
    v_dot2c_f32_bf16 v195, s73, v149
    v_dot2c_f32_bf16 v195, s73, v150
    v_dot2c_f32_bf16 v195, s73, v151
    s_waitcnt lgkmcnt(2)
    v_dot2c_f32_bf16 v195, s73, v152
    v_dot2c_f32_bf16 v195, s73, v153
    v_dot2c_f32_bf16 v195, s73, v154
    v_dot2c_f32_bf16 v195, s73, v155
    s_waitcnt lgkmcnt(0)
    v_dot2c_f32_bf16 v195, s73, v156
    v_dot2c_f32_bf16 v195, s73, v157
    v_dot2c_f32_bf16 v195, s73, v158
    v_dot2c_f32_bf16 v195, s73, v159
    v_mfma_f32_32x32x16_bf16 v[128:143], v[144:147], v[112:115], v[128:143]
    v_add_f32 v200, v200, v201
    v_add_f32 v202, v202, v203
    v_add_f32 v195, v195, v200
    v_add_f32 v195, v195, v202
    v_cvt_pk_bf16_f32 v200, 0, v195
    v_sub_f32 v201, v195, v200
    v_cvt_pk_bf16_f32 v196, v200, v200
    v_cvt_pk_bf16_f32 v197, v201, 0
    v_mfma_f32_32x32x16_bf16 v[128:143], v[148:151], v[116:119], v[128:143]
    v_mfma_f32_32x32x16_bf16 v[128:143], v[152:155], v[120:123], v[128:143]
    v_mfma_f32_32x32x16_bf16 v[128:143], v[156:159], v[124:127], v[128:143]
    v_mfma_f32_32x32x16_bf16 v[128:143], v[196:199], v[188:191], v[128:143]
    s_mov_b64 exec, 1
    ds_add_u32 v2, v3 offset:112
    s_mov_b64 exec, -1
    s_nop 8
    v_cvt_pk_bf16_f32 v204, v128, v129
    v_cvt_pk_bf16_f32 v205, v130, v131
    v_cvt_pk_bf16_f32 v206, v132, v133
    v_cvt_pk_bf16_f32 v207, v134, v135
    v_cvt_pk_bf16_f32 v208, v136, v137
    v_cvt_pk_bf16_f32 v209, v138, v139
    v_cvt_pk_bf16_f32 v210, v140, v141
    v_cvt_pk_bf16_f32 v211, v142, v143
    v_and_b32 v210, v210, v11
    v_and_b32 v211, v211, v11
    v_mfma_f32_32x32x16_bf16 v[212:227], v[176:179], v[204:207], 0
    s_nop 0
    v_mfma_f32_32x32x16_bf16 v[212:227], v[180:183], v[208:211], v[212:227]
    s_nop 11
    v_max3_f32 v16, v212, v213, v214
    v_min3_f32 v18, v212, v213, v214
    v_max3_f32 v16, v16, v215, v216
    v_min3_f32 v18, v18, v215, v216
    v_max3_f32 v16, v16, v217, v218
    v_min3_f32 v18, v18, v217, v218
    v_max3_f32 v16, v16, v220, v221
    v_min3_f32 v18, v18, v220, v221
    v_max3_f32 v16, v16, v222, v223
    v_min3_f32 v18, v18, v222, v223
    v_max3_f32 v16, v16, v224, v225
    v_min3_f32 v18, v18, v224, v225
    v_max_f32 v16, v16, v226
    v_min_f32 v18, v18, v226
    v_mov_b32 v17, v16
    v_mov_b32 v19, v18
    s_nop 0
    v_permlane32_swap_b32 v16, v17
    v_permlane32_swap_b32 v18, v19
    v_max_f32 v16, v16, v17
    v_min_f32 v18, v18, v19
    v_mul_f32 v16, v16, v194
    v_mul_f32 v18, v18, v194
    v_pk_fma_f32 v[228:229], v[212:213], v[194:195], v[18:19] op_sel_hi:[1,0,0] neg_lo:[1,0,0] neg_hi:[1,0,0]
    v_pk_fma_f32 v[212:213], v[212:213], v[194:195], v[16:17] op_sel_hi:[1,0,0] neg_lo:[0,0,1] neg_hi:[0,0,1]
    v_pk_fma_f32 v[230:231], v[214:215], v[194:195], v[18:19] op_sel_hi:[1,0,0] neg_lo:[1,0,0] neg_hi:[1,0,0]
    v_pk_fma_f32 v[214:215], v[214:215], v[194:195], v[16:17] op_sel_hi:[1,0,0] neg_lo:[0,0,1] neg_hi:[0,0,1]
    v_pk_fma_f32 v[232:233], v[216:217], v[194:195], v[18:19] op_sel_hi:[1,0,0] neg_lo:[1,0,0] neg_hi:[1,0,0]
    v_pk_fma_f32 v[216:217], v[216:217], v[194:195], v[16:17] op_sel_hi:[1,0,0] neg_lo:[0,0,1] neg_hi:[0,0,1]
    v_pk_fma_f32 v[234:235], v[218:219], v[194:195], v[18:19] op_sel_hi:[1,0,0] neg_lo:[1,0,0] neg_hi:[1,0,0]
    v_pk_fma_f32 v[218:219], v[218:219], v[194:195], v[16:17] op_sel_hi:[1,0,0] neg_lo:[0,0,1] neg_hi:[0,0,1]
    v_pk_fma_f32 v[236:237], v[220:221], v[194:195], v[18:19] op_sel_hi:[1,0,0] neg_lo:[1,0,0] neg_hi:[1,0,0]
    v_pk_fma_f32 v[220:221], v[220:221], v[194:195], v[16:17] op_sel_hi:[1,0,0] neg_lo:[0,0,1] neg_hi:[0,0,1]
    v_pk_fma_f32 v[238:239], v[222:223], v[194:195], v[18:19] op_sel_hi:[1,0,0] neg_lo:[1,0,0] neg_hi:[1,0,0]
    v_pk_fma_f32 v[222:223], v[222:223], v[194:195], v[16:17] op_sel_hi:[1,0,0] neg_lo:[0,0,1] neg_hi:[0,0,1]
    v_pk_fma_f32 v[240:241], v[224:225], v[194:195], v[18:19] op_sel_hi:[1,0,0] neg_lo:[1,0,0] neg_hi:[1,0,0]
    v_pk_fma_f32 v[224:225], v[224:225], v[194:195], v[16:17] op_sel_hi:[1,0,0] neg_lo:[0,0,1] neg_hi:[0,0,1]
    v_pk_fma_f32 v[242:243], v[226:227], v[194:195], v[18:19] op_sel_hi:[1,0,0] neg_lo:[1,0,0] neg_hi:[1,0,0]
    v_pk_fma_f32 v[226:227], v[226:227], v[194:195], v[16:17] op_sel_hi:[1,0,0] neg_lo:[0,0,1] neg_hi:[0,0,1]
    v_exp_f32 v228, v228
    v_exp_f32 v212, v212
    v_exp_f32 v229, v229
    v_exp_f32 v213, v213
    v_exp_f32 v230, v230
    v_exp_f32 v214, v214
    v_exp_f32 v231, v231
    v_exp_f32 v215, v215
    v_exp_f32 v232, v232
    v_exp_f32 v216, v216
    v_exp_f32 v233, v233
    v_exp_f32 v217, v217
    v_exp_f32 v234, v234
    v_exp_f32 v218, v218
    v_exp_f32 v236, v236
    v_exp_f32 v220, v220
    v_exp_f32 v237, v237
    v_exp_f32 v221, v221
    v_exp_f32 v238, v238
    v_exp_f32 v222, v222
    v_exp_f32 v239, v239
    v_exp_f32 v223, v223
    v_exp_f32 v240, v240
    v_exp_f32 v224, v224
    v_exp_f32 v241, v241
    v_exp_f32 v225, v225
    v_exp_f32 v242, v242
    v_exp_f32 v226, v226
    v_mov_b32 v235, 0
    v_mov_b32 v219, 0
    v_mov_b32 v243, 0
    v_mov_b32 v227, 0
    v_pk_add_f32 v[20:21], v[212:213], v[214:215]
    v_pk_add_f32 v[22:23], v[228:229], v[230:231]
    v_pk_add_f32 v[20:21], v[20:21], v[216:217]
    v_pk_add_f32 v[22:23], v[22:23], v[232:233]
    v_pk_add_f32 v[20:21], v[20:21], v[218:219]
    v_pk_add_f32 v[22:23], v[22:23], v[234:235]
    v_pk_add_f32 v[20:21], v[20:21], v[220:221]
    v_pk_add_f32 v[22:23], v[22:23], v[236:237]
    v_pk_add_f32 v[20:21], v[20:21], v[222:223]
    v_pk_add_f32 v[22:23], v[22:23], v[238:239]
    v_pk_add_f32 v[20:21], v[20:21], v[224:225]
    v_pk_add_f32 v[22:23], v[22:23], v[240:241]
    v_pk_add_f32 v[20:21], v[20:21], v[226:227]
    v_pk_add_f32 v[22:23], v[22:23], v[242:243]
    v_add_f32 v20, v20, v21
    v_add_f32 v22, v22, v23
    v_mov_b32 v17, v20
    v_mov_b32 v19, v22
    s_nop 0
    v_permlane32_swap_b32 v20, v17
    v_permlane32_swap_b32 v22, v19
    v_add_f32 v20, v20, v17
    v_add_f32 v22, v22, v19
    v_rcp_f32 v20, v20
    v_rcp_f32 v22, v22
    v_pk_mul_f32 v[212:213], v[212:213], v[20:21] op_sel_hi:[1,0]
    v_pk_mul_f32 v[228:229], v[228:229], v[22:23] op_sel_hi:[1,0]
    v_pk_mul_f32 v[214:215], v[214:215], v[20:21] op_sel_hi:[1,0]
    v_pk_mul_f32 v[230:231], v[230:231], v[22:23] op_sel_hi:[1,0]
    v_pk_mul_f32 v[216:217], v[216:217], v[20:21] op_sel_hi:[1,0]
    v_pk_mul_f32 v[232:233], v[232:233], v[22:23] op_sel_hi:[1,0]
    v_pk_mul_f32 v[218:219], v[218:219], v[20:21] op_sel_hi:[1,0]
    v_pk_mul_f32 v[234:235], v[234:235], v[22:23] op_sel_hi:[1,0]
    v_pk_mul_f32 v[220:221], v[220:221], v[20:21] op_sel_hi:[1,0]
    v_pk_mul_f32 v[236:237], v[236:237], v[22:23] op_sel_hi:[1,0]
    v_pk_mul_f32 v[222:223], v[222:223], v[20:21] op_sel_hi:[1,0]
    v_pk_mul_f32 v[238:239], v[238:239], v[22:23] op_sel_hi:[1,0]
    v_pk_mul_f32 v[224:225], v[224:225], v[20:21] op_sel_hi:[1,0]
    v_pk_mul_f32 v[240:241], v[240:241], v[22:23] op_sel_hi:[1,0]
    v_pk_mul_f32 v[226:227], v[226:227], v[20:21] op_sel_hi:[1,0]
    v_pk_mul_f32 v[242:243], v[242:243], v[22:23] op_sel_hi:[1,0]
    v_cvt_pk_bf16_f32 v128, v212, v213
    v_cvt_pk_bf16_f32 v136, v228, v229
    v_cvt_pk_bf16_f32 v129, v214, v215
    v_cvt_pk_bf16_f32 v137, v230, v231
    v_cvt_pk_bf16_f32 v130, v216, v217
    v_cvt_pk_bf16_f32 v138, v232, v233
    v_cvt_pk_bf16_f32 v131, v218, 0
    v_cvt_pk_bf16_f32 v139, v234, 0
    v_cvt_pk_bf16_f32 v132, v220, v221
    v_cvt_pk_bf16_f32 v140, v236, v237
    v_cvt_pk_bf16_f32 v133, v222, v223
    v_cvt_pk_bf16_f32 v141, v238, v239
    v_cvt_pk_bf16_f32 v134, v224, v225
    v_cvt_pk_bf16_f32 v142, v240, v241
    v_cvt_pk_bf16_f32 v135, v226, 0
    v_cvt_pk_bf16_f32 v143, v242, 0
    v_lshrrev_b32 v5, 4, v1
    v_lshlrev_b32 v6, 2, v5
    v_and_b32 v4, 15, v1
    v_xor_b32 v4, v4, v6
    v_mul_u32_u24 v5, 3584, v5
    v_lshl_add_u32 v78, v4, 4, v5
    s_lshl_b32 s60, s45, 8
    v_add_u32 v78, s60, v78
    s_cmp_ge_u32 s45, 14
    s_cbranch_scc1 bnb_127
    s_mov_b32 s59, 0
cw_128:
    ds_read_b32 v4, v2 offset:112
    s_add_u32 s59, s59, 1
    s_lshr_b32 s3, s59, 20
    s_waitcnt lgkmcnt(0)
    v_readfirstlane_b32 s60, v4
    s_nop 0
    s_max_u32 s60, s60, s3
    s_cmp_lt_u32 s60, 4
    s_cbranch_scc1 cw_128
    s_mov_b32 s59, 0
cw_129:
    ds_read_b32 v4, v2 offset:108
    s_add_u32 s59, s59, 1
    s_lshr_b32 s3, s59, 20
    s_waitcnt lgkmcnt(0)
    v_readfirstlane_b32 s60, v4
    s_nop 0
    s_max_u32 s60, s60, s3
    s_cmp_lt_u32 s60, 4
    s_cbranch_scc1 cw_129
    s_lshl_b32 s68, s47, 2
    s_lshr_b32 s68, 0x3210, s68
    s_and_b32 s68, s68, 15
    s_lshl_b32 s67, s68, 13
    s_add_u32 s66, s68, s52
    s_cmp_ge_u32 s66, 14
    s_cselect_b32 s60, 14, 0
    s_sub_u32 s66, s66, s60
    s_mul_i32 s66, s66, 114688
    s_add_u32 m0, s67, 0
    s_nop 0
    buffer_load_dwordx4 v78, s[24:27], s66 offen lds
    s_add_u32 m0, s67, 1024
    s_add_u32 s66, s66, 14336
    buffer_load_dwordx4 v78, s[24:27], s66 offen lds
    s_add_u32 m0, s67, 2048
    s_add_u32 s66, s66, 14336
    buffer_load_dwordx4 v78, s[24:27], s66 offen lds
    s_add_u32 m0, s67, 3072
    s_add_u32 s66, s66, 14336
    buffer_load_dwordx4 v78, s[24:27], s66 offen lds
    s_add_u32 m0, s67, 4096
    s_add_u32 s66, s66, 14336
    buffer_load_dwordx4 v78, s[24:27], s66 offen lds
    s_add_u32 m0, s67, 5120
    s_add_u32 s66, s66, 14336
    buffer_load_dwordx4 v78, s[24:27], s66 offen lds
    s_add_u32 m0, s67, 6144
    s_add_u32 s66, s66, 14336
    buffer_load_dwordx4 v78, s[24:27], s66 offen lds
    s_add_u32 m0, s67, 7168
    s_add_u32 s66, s66, 14336
    buffer_load_dwordx4 v78, s[24:27], s66 offen lds
bnb_127:
    s_setprio 3
    s_mov_b32 s59, 0
cw_130:
    ds_read_b32 v4, v2 offset:12
    s_add_u32 s59, s59, 1
    s_lshr_b32 s3, s59, 20
    s_waitcnt lgkmcnt(0)
    v_readfirstlane_b32 s60, v4
    s_nop 0
    s_max_u32 s60, s60, s3
    s_cmp_lt_u32 s60, 4
    s_cbranch_scc1 cw_130
    ds_read_b128 v[96:99], v13 offset:0
    ds_read_b128 v[100:103], v13 offset:1024
    ds_read_b128 v[104:107], v13 offset:2048
    ds_read_b128 v[108:111], v13 offset:3072
    s_waitcnt lgkmcnt(3)
    v_mfma_f32_32x32x16_bf16 v[112:127], v[96:99], v[128:131], 0
    s_waitcnt lgkmcnt(2)
    v_mfma_f32_32x32x16_bf16 v[112:127], v[100:103], v[132:135], v[112:127]
    s_waitcnt lgkmcnt(1)
    v_mfma_f32_32x32x16_bf16 v[112:127], v[104:107], v[136:139], v[112:127]
    s_waitcnt lgkmcnt(0)
    v_mfma_f32_32x32x16_bf16 v[112:127], v[108:111], v[140:143], v[112:127]
    s_nop 11
    v_add_f32 v14, 0x358637bd, v119
    v_rcp_f32 v14, v14
    s_nop 0
    v_pk_mul_f32 v[112:113], v[112:113], v[14:15] op_sel_hi:[1,0]
    v_pk_mul_f32 v[114:115], v[114:115], v[14:15] op_sel_hi:[1,0]
    v_pk_mul_f32 v[116:117], v[116:117], v[14:15] op_sel_hi:[1,0]
    v_pk_mul_f32 v[118:119], v[118:119], v[14:15] op_sel_hi:[1,0]
    v_pk_mul_f32 v[120:121], v[120:121], v[14:15] op_sel_hi:[1,0]
    v_pk_mul_f32 v[122:123], v[122:123], v[14:15] op_sel_hi:[1,0]
    v_pk_mul_f32 v[124:125], v[124:125], v[14:15] op_sel_hi:[1,0]
    v_pk_mul_f32 v[126:127], v[126:127], v[14:15] op_sel_hi:[1,0]
    v_cvt_pk_bf16_f32 v96, v112, v113
    v_cvt_pk_bf16_f32 v97, v114, v115
    v_cvt_pk_bf16_f32 v98, v116, v117
    v_cvt_pk_bf16_f32 v99, v118, v8
    buffer_store_dwordx4 v[96:99], v12, s[40:43], s62 offen sc1
    v_cvt_pk_bf16_f32 v100, v120, v121
    v_cvt_pk_bf16_f32 v101, v122, v123
    v_cvt_pk_bf16_f32 v102, v124, v125
    v_cvt_pk_bf16_f32 v103, v126, v8
    buffer_store_dwordx4 v[100:103], v12, s[40:43], s62 offen offset:512 sc1
    s_mov_b64 exec, 1
    ds_add_u32 v2, v3 offset:16
    s_mov_b64 exec, -1
    s_setprio 0
    s_cmp_ge_u32 s45, 14
    s_cbranch_scc1 bidle_131
    s_lshl_b32 s68, s47, 2
    s_lshr_b32 s68, 0x9876, s68
    s_and_b32 s68, s68, 15
    s_lshl_b32 s67, s68, 13
    s_add_u32 s66, s68, s52
    s_cmp_ge_u32 s66, 14
    s_cselect_b32 s60, 14, 0
    s_sub_u32 s66, s66, s60
    s_mul_i32 s66, s66, 114688
    s_add_u32 m0, s67, 0
    s_nop 0
    buffer_load_dwordx4 v78, s[24:27], s66 offen lds
    s_add_u32 m0, s67, 1024
    s_add_u32 s66, s66, 14336
    buffer_load_dwordx4 v78, s[24:27], s66 offen lds
    s_add_u32 m0, s67, 2048
    s_add_u32 s66, s66, 14336
    buffer_load_dwordx4 v78, s[24:27], s66 offen lds
    s_add_u32 m0, s67, 3072
    s_add_u32 s66, s66, 14336
    buffer_load_dwordx4 v78, s[24:27], s66 offen lds
    s_add_u32 m0, s67, 4096
    s_add_u32 s66, s66, 14336
    buffer_load_dwordx4 v78, s[24:27], s66 offen lds
    s_add_u32 m0, s67, 5120
    s_add_u32 s66, s66, 14336
    buffer_load_dwordx4 v78, s[24:27], s66 offen lds
    s_add_u32 m0, s67, 6144
    s_add_u32 s66, s66, 14336
    buffer_load_dwordx4 v78, s[24:27], s66 offen lds
    s_add_u32 m0, s67, 7168
    s_add_u32 s66, s66, 14336
    buffer_load_dwordx4 v78, s[24:27], s66 offen lds
    v_and_b32 v13, 31, v1
    v_lshlrev_b32 v13, 1, v13
    s_lshl_b32 s62, s45, 8
    s_lshl_b32 s63, s47, 6
    s_add_u32 s62, s62, s63
    buffer_load_ushort v20, v13, s[28:31], s62 offen
    v_lshrrev_b32 v4, 5, v1
    v_bfe_u32 v5, v1, 2, 2
    v_lshl_add_u32 v4, v4, 2, v5
    v_lshlrev_b32 v4, 8, v4
    v_lshl_add_u32 v4, v5, 6, v4
    v_bfe_u32 v5, v1, 4, 1
    v_lshl_add_u32 v4, v5, 5, v4
    v_and_b32 v5, 3, v1
    v_lshl_add_u32 v9, v5, 3, v4
    v_xor_b32 v9, s63, v9
    v_add_u32 v10, 57344, v9
    v_lshlrev_b32 v15, 4, v1
    s_lshl_b32 s63, s47, 10
    s_add_u32 s63, s63, 147456
    v_add_u32 v15, s63, v15
    v_mov_b32 v16, 0
    v_mov_b32 v17, 0
    s_mov_b32 s59, 0
cw_132:
    s_sleep 1
    ds_read_b32 v4, v2 offset:4
    s_add_u32 s59, s59, 1
    s_lshr_b32 s3, s59, 20
    s_waitcnt lgkmcnt(0)
    v_readfirstlane_b32 s60, v4
    s_nop 0
    s_max_u32 s60, s60, s3
    s_cmp_lt_u32 s60, 4
    s_cbranch_scc1 cw_132
    s_mov_b32 s59, 0
cw_133:
    s_sleep 1
    ds_read_b32 v4, v2 offset:56
    s_add_u32 s59, s59, 1
    s_lshr_b32 s3, s59, 20
    s_waitcnt lgkmcnt(0)
    v_readfirstlane_b32 s60, v4
    s_nop 0
    s_max_u32 s60, s60, s3
    s_cmp_lt_u32 s60, 4
    s_cbranch_scc1 cw_133
    s_lshl_b32 s68, s47, 2
    s_lshr_b32 s68, 0xdcba, s68
    s_and_b32 s68, s68, 15
    s_lshl_b32 s67, s68, 13
    s_add_u32 s66, s68, s52
    s_cmp_ge_u32 s66, 14
    s_cselect_b32 s60, 14, 0
    s_sub_u32 s66, s66, s60
    s_mul_i32 s66, s66, 114688
    s_add_u32 m0, s67, 0
    s_nop 0
    buffer_load_dwordx4 v78, s[24:27], s66 offen lds
    s_add_u32 m0, s67, 1024
    s_add_u32 s66, s66, 14336
    buffer_load_dwordx4 v78, s[24:27], s66 offen lds
    s_add_u32 m0, s67, 2048
    s_add_u32 s66, s66, 14336
    buffer_load_dwordx4 v78, s[24:27], s66 offen lds
    s_add_u32 m0, s67, 3072
    s_add_u32 s66, s66, 14336
    buffer_load_dwordx4 v78, s[24:27], s66 offen lds
    s_add_u32 m0, s67, 4096
    s_add_u32 s66, s66, 14336
    buffer_load_dwordx4 v78, s[24:27], s66 offen lds
    s_add_u32 m0, s67, 5120
    s_add_u32 s66, s66, 14336
    buffer_load_dwordx4 v78, s[24:27], s66 offen lds
    s_add_u32 m0, s67, 6144
    s_add_u32 s66, s66, 14336
    buffer_load_dwordx4 v78, s[24:27], s66 offen lds
    s_add_u32 m0, s67, 7168
    s_add_u32 s66, s66, 14336
    buffer_load_dwordx4 v78, s[24:27], s66 offen lds
    s_waitcnt vmcnt(0)
    s_mov_b64 exec, 1
    ds_add_u32 v2, v3 offset:8
    s_mov_b64 exec, -1
    s_mov_b32 s59, 0
cw_134:
    ds_read_b32 v4, v2 offset:8
    s_add_u32 s59, s59, 1
    s_lshr_b32 s3, s59, 20
    s_waitcnt lgkmcnt(0)
    v_readfirstlane_b32 s60, v4
    s_nop 0
    s_max_u32 s60, s60, s3
    s_cmp_lt_u32 s60, 4
    s_cbranch_scc1 cw_134
    ds_read_b64_tr_b16 v[32:33], v9 offset:0
    ds_read_b64_tr_b16 v[34:35], v9 offset:2048
    ds_read_b64_tr_b16 v[36:37], v9 offset:4096
    ds_read_b64_tr_b16 v[38:39], v9 offset:6144
    ds_read_b64_tr_b16 v[40:41], v9 offset:8192
    ds_read_b64_tr_b16 v[42:43], v9 offset:10240
    ds_read_b64_tr_b16 v[44:45], v9 offset:12288
    ds_read_b64_tr_b16 v[46:47], v9 offset:14336
    ds_read_b64_tr_b16 v[48:49], v9 offset:16384
    ds_read_b64_tr_b16 v[50:51], v9 offset:18432
    ds_read_b64_tr_b16 v[52:53], v9 offset:20480
    ds_read_b64_tr_b16 v[54:55], v9 offset:22528
    s_waitcnt lgkmcnt(10)
    v_dot2c_f32_bf16 v16, s73, v32
    v_dot2c_f32_bf16 v17, s73, v33
    v_dot2c_f32_bf16 v16, s73, v34
    v_dot2c_f32_bf16 v17, s73, v35
    ds_read_b64_tr_b16 v[56:57], v9 offset:24576
    ds_read_b64_tr_b16 v[58:59], v9 offset:26624
    s_waitcnt lgkmcnt(10)
    v_dot2c_f32_bf16 v16, s73, v36
    v_dot2c_f32_bf16 v17, s73, v37
    v_dot2c_f32_bf16 v16, s73, v38
    v_dot2c_f32_bf16 v17, s73, v39
    ds_read_b64_tr_b16 v[60:61], v9 offset:28672
    ds_read_b64_tr_b16 v[62:63], v9 offset:30720
    s_waitcnt lgkmcnt(10)
    v_dot2c_f32_bf16 v16, s73, v40
    v_dot2c_f32_bf16 v17, s73, v41
    v_dot2c_f32_bf16 v16, s73, v42
    v_dot2c_f32_bf16 v17, s73, v43
    ds_read_b64_tr_b16 v[64:65], v9 offset:32768
    ds_read_b64_tr_b16 v[66:67], v9 offset:34816
    s_waitcnt lgkmcnt(10)
    v_dot2c_f32_bf16 v16, s73, v44
    v_dot2c_f32_bf16 v17, s73, v45
    v_dot2c_f32_bf16 v16, s73, v46
    v_dot2c_f32_bf16 v17, s73, v47
    ds_read_b64_tr_b16 v[68:69], v9 offset:36864
    ds_read_b64_tr_b16 v[70:71], v9 offset:38912
    s_waitcnt lgkmcnt(10)
    v_dot2c_f32_bf16 v16, s73, v48
    v_dot2c_f32_bf16 v17, s73, v49
    v_dot2c_f32_bf16 v16, s73, v50
    v_dot2c_f32_bf16 v17, s73, v51
    ds_read_b64_tr_b16 v[72:73], v9 offset:40960
    ds_read_b64_tr_b16 v[74:75], v9 offset:43008
    s_waitcnt lgkmcnt(10)
    v_dot2c_f32_bf16 v16, s73, v52
    v_dot2c_f32_bf16 v17, s73, v53
    v_dot2c_f32_bf16 v16, s73, v54
    v_dot2c_f32_bf16 v17, s73, v55
    ds_read_b64_tr_b16 v[76:77], v9 offset:45056
    ds_read_b64_tr_b16 v[78:79], v9 offset:47104
    s_waitcnt lgkmcnt(10)
    v_dot2c_f32_bf16 v16, s73, v56
    v_dot2c_f32_bf16 v17, s73, v57
    v_dot2c_f32_bf16 v16, s73, v58
    v_dot2c_f32_bf16 v17, s73, v59
    ds_read_b64_tr_b16 v[80:81], v9 offset:49152
    ds_read_b64_tr_b16 v[82:83], v9 offset:51200
    s_waitcnt lgkmcnt(10)
    v_dot2c_f32_bf16 v16, s73, v60
    v_dot2c_f32_bf16 v17, s73, v61
    v_dot2c_f32_bf16 v16, s73, v62
    v_dot2c_f32_bf16 v17, s73, v63
    ds_read_b64_tr_b16 v[84:85], v9 offset:53248
    ds_read_b64_tr_b16 v[86:87], v9 offset:55296
    s_waitcnt lgkmcnt(10)
    v_dot2c_f32_bf16 v16, s73, v64
    v_dot2c_f32_bf16 v17, s73, v65
    v_dot2c_f32_bf16 v16, s73, v66
    v_dot2c_f32_bf16 v17, s73, v67
    ds_read_b64_tr_b16 v[88:89], v10 offset:0
    ds_read_b64_tr_b16 v[90:91], v10 offset:2048
    s_waitcnt lgkmcnt(10)
    v_dot2c_f32_bf16 v16, s73, v68
    v_dot2c_f32_bf16 v17, s73, v69
    v_dot2c_f32_bf16 v16, s73, v70
    v_dot2c_f32_bf16 v17, s73, v71
    ds_read_b64_tr_b16 v[92:93], v10 offset:4096
    ds_read_b64_tr_b16 v[94:95], v10 offset:6144
    s_waitcnt lgkmcnt(10)
    v_dot2c_f32_bf16 v16, s73, v72
    v_dot2c_f32_bf16 v17, s73, v73
    v_dot2c_f32_bf16 v16, s73, v74
    v_dot2c_f32_bf16 v17, s73, v75
    ds_read_b64_tr_b16 v[96:97], v10 offset:8192
    ds_read_b64_tr_b16 v[98:99], v10 offset:10240
    s_waitcnt lgkmcnt(10)
    v_dot2c_f32_bf16 v16, s73, v76
    v_dot2c_f32_bf16 v17, s73, v77
    v_dot2c_f32_bf16 v16, s73, v78
    v_dot2c_f32_bf16 v17, s73, v79
    ds_read_b64_tr_b16 v[100:101], v10 offset:12288
    ds_read_b64_tr_b16 v[102:103], v10 offset:14336
    s_waitcnt lgkmcnt(10)
    v_dot2c_f32_bf16 v16, s73, v80
    v_dot2c_f32_bf16 v17, s73, v81
    v_dot2c_f32_bf16 v16, s73, v82
    v_dot2c_f32_bf16 v17, s73, v83
    ds_read_b64_tr_b16 v[104:105], v10 offset:16384
    ds_read_b64_tr_b16 v[106:107], v10 offset:18432
    s_waitcnt lgkmcnt(10)
    v_dot2c_f32_bf16 v16, s73, v84
    v_dot2c_f32_bf16 v17, s73, v85
    v_dot2c_f32_bf16 v16, s73, v86
    v_dot2c_f32_bf16 v17, s73, v87
    ds_read_b64_tr_b16 v[108:109], v10 offset:20480
    ds_read_b64_tr_b16 v[110:111], v10 offset:22528
    s_waitcnt lgkmcnt(10)
    v_dot2c_f32_bf16 v16, s73, v88
    v_dot2c_f32_bf16 v17, s73, v89
    v_dot2c_f32_bf16 v16, s73, v90
    v_dot2c_f32_bf16 v17, s73, v91
    ds_read_b64_tr_b16 v[112:113], v10 offset:24576
    ds_read_b64_tr_b16 v[114:115], v10 offset:26624
    s_waitcnt lgkmcnt(10)
    v_dot2c_f32_bf16 v16, s73, v92
    v_dot2c_f32_bf16 v17, s73, v93
    v_dot2c_f32_bf16 v16, s73, v94
    v_dot2c_f32_bf16 v17, s73, v95
    ds_read_b64_tr_b16 v[116:117], v10 offset:28672
    ds_read_b64_tr_b16 v[118:119], v10 offset:30720
    s_waitcnt lgkmcnt(10)
    v_dot2c_f32_bf16 v16, s73, v96
    v_dot2c_f32_bf16 v17, s73, v97
    v_dot2c_f32_bf16 v16, s73, v98
    v_dot2c_f32_bf16 v17, s73, v99
    ds_read_b64_tr_b16 v[120:121], v10 offset:32768
    ds_read_b64_tr_b16 v[122:123], v10 offset:34816
    s_waitcnt lgkmcnt(10)
    v_dot2c_f32_bf16 v16, s73, v100
    v_dot2c_f32_bf16 v17, s73, v101
    v_dot2c_f32_bf16 v16, s73, v102
    v_dot2c_f32_bf16 v17, s73, v103
    ds_read_b64_tr_b16 v[124:125], v10 offset:36864
    ds_read_b64_tr_b16 v[126:127], v10 offset:38912
    s_waitcnt lgkmcnt(10)
    v_dot2c_f32_bf16 v16, s73, v104
    v_dot2c_f32_bf16 v17, s73, v105
    v_dot2c_f32_bf16 v16, s73, v106
    v_dot2c_f32_bf16 v17, s73, v107
    ds_read_b64_tr_b16 v[128:129], v10 offset:40960
    ds_read_b64_tr_b16 v[130:131], v10 offset:43008
    s_waitcnt lgkmcnt(10)
    v_dot2c_f32_bf16 v16, s73, v108
    v_dot2c_f32_bf16 v17, s73, v109
    v_dot2c_f32_bf16 v16, s73, v110
    v_dot2c_f32_bf16 v17, s73, v111
    ds_read_b64_tr_b16 v[132:133], v10 offset:45056
    ds_read_b64_tr_b16 v[134:135], v10 offset:47104
    s_waitcnt lgkmcnt(10)
    v_dot2c_f32_bf16 v16, s73, v112
    v_dot2c_f32_bf16 v17, s73, v113
    v_dot2c_f32_bf16 v16, s73, v114
    v_dot2c_f32_bf16 v17, s73, v115
    ds_read_b64_tr_b16 v[136:137], v10 offset:49152
    ds_read_b64_tr_b16 v[138:139], v10 offset:51200
    s_waitcnt lgkmcnt(10)
    v_dot2c_f32_bf16 v16, s73, v116
    v_dot2c_f32_bf16 v17, s73, v117
    v_dot2c_f32_bf16 v16, s73, v118
    v_dot2c_f32_bf16 v17, s73, v119
    ds_read_b64_tr_b16 v[140:141], v10 offset:53248
    ds_read_b64_tr_b16 v[142:143], v10 offset:55296
    s_waitcnt lgkmcnt(10)
    v_dot2c_f32_bf16 v16, s73, v120
    v_dot2c_f32_bf16 v17, s73, v121
    v_dot2c_f32_bf16 v16, s73, v122
    v_dot2c_f32_bf16 v17, s73, v123
    s_waitcnt lgkmcnt(8)
    v_dot2c_f32_bf16 v16, s73, v124
    v_dot2c_f32_bf16 v17, s73, v125
    v_dot2c_f32_bf16 v16, s73, v126
    v_dot2c_f32_bf16 v17, s73, v127
    s_waitcnt lgkmcnt(6)
    v_dot2c_f32_bf16 v16, s73, v128
    v_dot2c_f32_bf16 v17, s73, v129
    v_dot2c_f32_bf16 v16, s73, v130
    v_dot2c_f32_bf16 v17, s73, v131
    s_waitcnt lgkmcnt(4)
    v_dot2c_f32_bf16 v16, s73, v132
    v_dot2c_f32_bf16 v17, s73, v133
    v_dot2c_f32_bf16 v16, s73, v134
    v_dot2c_f32_bf16 v17, s73, v135
    s_waitcnt lgkmcnt(2)
    v_dot2c_f32_bf16 v16, s73, v136
    v_dot2c_f32_bf16 v17, s73, v137
    v_dot2c_f32_bf16 v16, s73, v138
    v_dot2c_f32_bf16 v17, s73, v139
    s_waitcnt lgkmcnt(0)
    v_dot2c_f32_bf16 v16, s73, v140
    v_dot2c_f32_bf16 v17, s73, v141
    v_dot2c_f32_bf16 v16, s73, v142
    v_dot2c_f32_bf16 v17, s73, v143
    v_lshlrev_b32 v20, 16, v20
    v_and_b32 v20, v20, v11
    s_nop 0
    v_add_f32 v16, v16, v17
    v_cvt_pk_bf16_f32 v18, 0, v16
    v_sub_f32 v19, v16, v18
    v_cvt_pk_bf16_f32 v24, v18, v18
    v_cvt_pk_bf16_f32 v25, v19, v20
    v_cvt_pk_bf16_f32 v26, v20, 0
    v_mov_b32 v27, 0
    ds_write_b128 v15, v[24:27]
    s_waitcnt lgkmcnt(0)
    s_mov_b64 exec, 1
    ds_add_u32 v2, v3 offset:20
    s_mov_b64 exec, -1
    v_lshrrev_b32 v4, 3, v1
    v_mul_u32_u24 v4, 896, v4
    v_bfe_u32 v5, v1, 4, 1
    v_lshlrev_b32 v5, 2, v5
    v_and_b32 v6, 7, v1
    v_xor_b32 v5, v5, v6
    v_lshl_add_u32 v8, v5, 4, v4
    s_mul_i32 s79, s56, 802816
    s_mul_i32 s63, s55, 57344
    s_add_u32 s79, s79, s63
    s_lshl_b32 s63, s54, 7
    s_add_u32 s79, s79, s63
    s_lshl_b32 s77, s47, 13
    v_lshlrev_b32 v9, 4, v1
    v_add_u32 v9, s77, v9
    s_mov_b32 s59, 0
cw_135:
    s_sleep 2
    ds_read_b32 v4, v2 offset:124
    s_add_u32 s59, s59, 1
    s_lshr_b32 s3, s59, 20
    s_waitcnt lgkmcnt(0)
    v_readfirstlane_b32 s60, v4
    s_nop 0
    s_max_u32 s60, s60, s3
    s_cmp_lt_u32 s60, 4
    s_cbranch_scc1 cw_135
    s_add_u32 s61, s100, 0
    s_cmp_ge_u32 s61, 7
    s_cselect_b32 s60, 7, 0
    s_sub_u32 s61, s61, s60
    s_mul_i32 s61, s61, 114688
    s_add_u32 s61, s61, s79
    s_add_u32 m0, s77, 114688
    s_nop 0
    buffer_load_dwordx4 v8, s[32:35], s61 offen lds
    s_add_u32 s61, s61, 7168
    s_add_u32 m0, s77, 115712
    s_nop 0
    buffer_load_dwordx4 v8, s[32:35], s61 offen lds
    s_add_u32 s61, s61, 7168
    s_add_u32 m0, s77, 116736
    s_nop 0
    buffer_load_dwordx4 v8, s[32:35], s61 offen lds
    s_add_u32 s61, s61, 7168
    s_add_u32 m0, s77, 117760
    s_nop 0
    buffer_load_dwordx4 v8, s[32:35], s61 offen lds
    s_add_u32 s61, s61, 7168
    s_add_u32 m0, s77, 118784
    s_nop 0
    buffer_load_dwordx4 v8, s[32:35], s61 offen lds
    s_add_u32 s61, s61, 7168
    s_add_u32 m0, s77, 119808
    s_nop 0
    buffer_load_dwordx4 v8, s[32:35], s61 offen lds
    s_add_u32 s61, s61, 7168
    s_add_u32 m0, s77, 120832
    s_nop 0
    buffer_load_dwordx4 v8, s[32:35], s61 offen lds
    s_add_u32 s61, s61, 7168
    s_add_u32 m0, s77, 121856
    s_nop 0
    buffer_load_dwordx4 v8, s[32:35], s61 offen lds
    s_add_u32 s61, s100, 1
    s_cmp_ge_u32 s61, 7
    s_cselect_b32 s60, 7, 0
    s_sub_u32 s61, s61, s60
    s_mul_i32 s61, s61, 114688
    s_add_u32 s61, s61, s79
    buffer_load_dwordx4 v[16:19], v8, s[32:35], s61 offen
    s_add_u32 s61, s61, 7168
    buffer_load_dwordx4 v[20:23], v8, s[32:35], s61 offen
    s_add_u32 s61, s61, 7168
    buffer_load_dwordx4 v[24:27], v8, s[32:35], s61 offen
    s_add_u32 s61, s61, 7168
    buffer_load_dwordx4 v[28:31], v8, s[32:35], s61 offen
    s_add_u32 s61, s61, 7168
    buffer_load_dwordx4 v[32:35], v8, s[32:35], s61 offen
    s_add_u32 s61, s61, 7168
    buffer_load_dwordx4 v[36:39], v8, s[32:35], s61 offen
    s_add_u32 s61, s61, 7168
    buffer_load_dwordx4 v[40:43], v8, s[32:35], s61 offen
    s_add_u32 s61, s61, 7168
    buffer_load_dwordx4 v[44:47], v8, s[32:35], s61 offen
    s_add_u32 s61, s100, 2
    s_cmp_ge_u32 s61, 7
    s_cselect_b32 s60, 7, 0
    s_sub_u32 s61, s61, s60
    s_mul_i32 s61, s61, 114688
    s_add_u32 s61, s61, s79
    buffer_load_dwordx4 v[48:51], v8, s[32:35], s61 offen
    s_add_u32 s61, s61, 7168
    buffer_load_dwordx4 v[52:55], v8, s[32:35], s61 offen
    s_add_u32 s61, s61, 7168
    buffer_load_dwordx4 v[56:59], v8, s[32:35], s61 offen
    s_add_u32 s61, s61, 7168
    buffer_load_dwordx4 v[60:63], v8, s[32:35], s61 offen
    s_add_u32 s61, s61, 7168
    buffer_load_dwordx4 v[64:67], v8, s[32:35], s61 offen
    s_add_u32 s61, s61, 7168
    buffer_load_dwordx4 v[68:71], v8, s[32:35], s61 offen
    s_add_u32 s61, s61, 7168
    buffer_load_dwordx4 v[72:75], v8, s[32:35], s61 offen
    s_add_u32 s61, s61, 7168
    buffer_load_dwordx4 v[76:79], v8, s[32:35], s61 offen
    s_add_u32 s61, s100, 3
    s_cmp_ge_u32 s61, 7
    s_cselect_b32 s60, 7, 0
    s_sub_u32 s61, s61, s60
    s_mul_i32 s61, s61, 114688
    s_add_u32 s61, s61, s79
    buffer_load_dwordx4 v[80:83], v8, s[32:35], s61 offen
    s_add_u32 s61, s61, 7168
    buffer_load_dwordx4 v[84:87], v8, s[32:35], s61 offen
    s_add_u32 s61, s61, 7168
    buffer_load_dwordx4 v[88:91], v8, s[32:35], s61 offen
    s_add_u32 s61, s61, 7168
    buffer_load_dwordx4 v[92:95], v8, s[32:35], s61 offen
    s_add_u32 s61, s61, 7168
    buffer_load_dwordx4 v[96:99], v8, s[32:35], s61 offen
    s_add_u32 s61, s61, 7168
    buffer_load_dwordx4 v[100:103], v8, s[32:35], s61 offen
    s_add_u32 s61, s61, 7168
    buffer_load_dwordx4 v[104:107], v8, s[32:35], s61 offen
    s_add_u32 s61, s61, 7168
    buffer_load_dwordx4 v[108:111], v8, s[32:35], s61 offen
    s_add_u32 s61, s100, 4
    s_cmp_ge_u32 s61, 7
    s_cselect_b32 s60, 7, 0
    s_sub_u32 s61, s61, s60
    s_mul_i32 s61, s61, 114688
    s_add_u32 s61, s61, s79
    buffer_load_dwordx4 v[112:115], v8, s[32:35], s61 offen
    s_add_u32 s61, s61, 7168
    buffer_load_dwordx4 v[116:119], v8, s[32:35], s61 offen
    s_add_u32 s61, s61, 7168
    buffer_load_dwordx4 v[120:123], v8, s[32:35], s61 offen
    s_add_u32 s61, s61, 7168
    buffer_load_dwordx4 v[124:127], v8, s[32:35], s61 offen
    s_add_u32 s61, s61, 7168
    buffer_load_dwordx4 v[128:131], v8, s[32:35], s61 offen
    s_add_u32 s61, s61, 7168
    buffer_load_dwordx4 v[132:135], v8, s[32:35], s61 offen
    s_add_u32 s61, s61, 7168
    buffer_load_dwordx4 v[136:139], v8, s[32:35], s61 offen
    s_add_u32 s61, s61, 7168
    buffer_load_dwordx4 v[140:143], v8, s[32:35], s61 offen
    s_add_u32 s61, s100, 5
    s_cmp_ge_u32 s61, 7
    s_cselect_b32 s60, 7, 0
    s_sub_u32 s61, s61, s60
    s_mul_i32 s61, s61, 114688
    s_add_u32 s61, s61, s79
    buffer_load_dwordx4 v[144:147], v8, s[32:35], s61 offen
    s_add_u32 s61, s61, 7168
    buffer_load_dwordx4 v[148:151], v8, s[32:35], s61 offen
    s_add_u32 s61, s61, 7168
    buffer_load_dwordx4 v[152:155], v8, s[32:35], s61 offen
    s_add_u32 s61, s61, 7168
    buffer_load_dwordx4 v[156:159], v8, s[32:35], s61 offen
    s_add_u32 s61, s61, 7168
    buffer_load_dwordx4 v[160:163], v8, s[32:35], s61 offen
    s_add_u32 s61, s61, 7168
    buffer_load_dwordx4 v[164:167], v8, s[32:35], s61 offen
    s_add_u32 s61, s61, 7168
    buffer_load_dwordx4 v[168:171], v8, s[32:35], s61 offen
    s_add_u32 s61, s61, 7168
    buffer_load_dwordx4 v[172:175], v8, s[32:35], s61 offen
    s_add_u32 s61, s100, 6
    s_cmp_ge_u32 s61, 7
    s_cselect_b32 s60, 7, 0
    s_sub_u32 s61, s61, s60
    s_mul_i32 s61, s61, 114688
    s_add_u32 s61, s61, s79
    buffer_load_dwordx4 v[176:179], v8, s[32:35], s61 offen
    s_add_u32 s61, s61, 7168
    buffer_load_dwordx4 v[180:183], v8, s[32:35], s61 offen
    s_add_u32 s61, s61, 7168
    buffer_load_dwordx4 v[184:187], v8, s[32:35], s61 offen
    s_add_u32 s61, s61, 7168
    buffer_load_dwordx4 v[188:191], v8, s[32:35], s61 offen
    s_add_u32 s61, s61, 7168
    buffer_load_dwordx4 v[192:195], v8, s[32:35], s61 offen
    s_add_u32 s61, s61, 7168
    buffer_load_dwordx4 v[196:199], v8, s[32:35], s61 offen
    s_add_u32 s61, s61, 7168
    buffer_load_dwordx4 v[200:203], v8, s[32:35], s61 offen
    s_add_u32 s61, s61, 7168
    buffer_load_dwordx4 v[204:207], v8, s[32:35], s61 offen
    s_waitcnt vmcnt(48)
    s_mov_b64 exec, 1
    ds_add_u32 v2, v3 offset:64
    s_mov_b64 exec, -1
    s_waitcnt vmcnt(40)
    s_mov_b32 s59, 0
cw_136:
    s_sleep 1
    ds_read_b32 v4, v2 offset:36
    s_add_u32 s59, s59, 1
    s_lshr_b32 s3, s59, 20
    s_waitcnt lgkmcnt(0)
    v_readfirstlane_b32 s60, v4
    s_nop 0
    s_max_u32 s60, s60, s3
    s_cmp_lt_u32 s60, 4
    s_cbranch_scc1 cw_136
    v_add_u32 v5, 0, v9
    ds_write_b128 v5, v[16:19] offset:0
    ds_write_b128 v5, v[20:23] offset:1024
    ds_write_b128 v5, v[24:27] offset:2048
    ds_write_b128 v5, v[28:31] offset:3072
    ds_write_b128 v5, v[32:35] offset:4096
    ds_write_b128 v5, v[36:39] offset:5120
    ds_write_b128 v5, v[40:43] offset:6144
    ds_write_b128 v5, v[44:47] offset:7168
    s_waitcnt lgkmcnt(0)
    s_mov_b64 exec, 1
    ds_add_u32 v2, v3 offset:68
    s_mov_b64 exec, -1
    s_waitcnt vmcnt(32)
    v_add_u32 v5, 32768, v9
    ds_write_b128 v5, v[48:51] offset:0
    ds_write_b128 v5, v[52:55] offset:1024
    ds_write_b128 v5, v[56:59] offset:2048
    ds_write_b128 v5, v[60:63] offset:3072
    ds_write_b128 v5, v[64:67] offset:4096
    ds_write_b128 v5, v[68:71] offset:5120
    ds_write_b128 v5, v[72:75] offset:6144
    ds_write_b128 v5, v[76:79] offset:7168
    s_waitcnt lgkmcnt(0)
    s_mov_b64 exec, 1
    ds_add_u32 v2, v3 offset:72
    s_mov_b64 exec, -1
    s_waitcnt vmcnt(24)
    v_add_u32 v5, 65536, v9
    ds_write_b128 v5, v[80:83] offset:0
    ds_write_b128 v5, v[84:87] offset:1024
    ds_write_b128 v5, v[88:91] offset:2048
    ds_write_b128 v5, v[92:95] offset:3072
    ds_write_b128 v5, v[96:99] offset:4096
    ds_write_b128 v5, v[100:103] offset:5120
    ds_write_b128 v5, v[104:107] offset:6144
    ds_write_b128 v5, v[108:111] offset:7168
    s_waitcnt lgkmcnt(0)
    s_mov_b64 exec, 1
    ds_add_u32 v2, v3 offset:76
    s_mov_b64 exec, -1
    s_waitcnt vmcnt(16)
    s_mov_b32 s59, 0
cw_137:
    s_sleep 1
    ds_read_b32 v4, v2 offset:96
    s_add_u32 s59, s59, 1
    s_lshr_b32 s3, s59, 20
    s_waitcnt lgkmcnt(0)
    v_readfirstlane_b32 s60, v4
    s_nop 0
    s_max_u32 s60, s60, s3
    s_cmp_lt_u32 s60, 4
    s_cbranch_scc1 cw_137
    v_add_u32 v5, 114688, v9
    ds_write_b128 v5, v[112:115] offset:0
    ds_write_b128 v5, v[116:119] offset:1024
    ds_write_b128 v5, v[120:123] offset:2048
    ds_write_b128 v5, v[124:127] offset:3072
    ds_write_b128 v5, v[128:131] offset:4096
    ds_write_b128 v5, v[132:135] offset:5120
    ds_write_b128 v5, v[136:139] offset:6144
    ds_write_b128 v5, v[140:143] offset:7168
    s_waitcnt lgkmcnt(0)
    s_mov_b64 exec, 1
    ds_add_u32 v2, v3 offset:80
    s_mov_b64 exec, -1
    s_waitcnt vmcnt(8)
    s_mov_b32 s59, 0
cw_138:
    s_sleep 1
    ds_read_b32 v4, v2 offset:100
    s_add_u32 s59, s59, 1
    s_lshr_b32 s3, s59, 20
    s_waitcnt lgkmcnt(0)
    v_readfirstlane_b32 s60, v4
    s_nop 0
    s_max_u32 s60, s60, s3
    s_cmp_lt_u32 s60, 4
    s_cbranch_scc1 cw_138
    v_add_u32 v5, 0, v9
    ds_write_b128 v5, v[144:147] offset:0
    ds_write_b128 v5, v[148:151] offset:1024
    ds_write_b128 v5, v[152:155] offset:2048
    ds_write_b128 v5, v[156:159] offset:3072
    ds_write_b128 v5, v[160:163] offset:4096
    ds_write_b128 v5, v[164:167] offset:5120
    ds_write_b128 v5, v[168:171] offset:6144
    ds_write_b128 v5, v[172:175] offset:7168
    s_waitcnt lgkmcnt(0)
    s_mov_b64 exec, 1
    ds_add_u32 v2, v3 offset:84
    s_mov_b64 exec, -1
    s_waitcnt vmcnt(0)
    s_mov_b32 s59, 0
cw_139:
    s_sleep 1
    ds_read_b32 v4, v2 offset:104
    s_add_u32 s59, s59, 1
    s_lshr_b32 s3, s59, 20
    s_waitcnt lgkmcnt(0)
    v_readfirstlane_b32 s60, v4
    s_nop 0
    s_max_u32 s60, s60, s3
    s_cmp_lt_u32 s60, 4
    s_cbranch_scc1 cw_139
    v_add_u32 v5, 32768, v9
    ds_write_b128 v5, v[176:179] offset:0
    ds_write_b128 v5, v[180:183] offset:1024
    ds_write_b128 v5, v[184:187] offset:2048
    ds_write_b128 v5, v[188:191] offset:3072
    ds_write_b128 v5, v[192:195] offset:4096
    ds_write_b128 v5, v[196:199] offset:5120
    ds_write_b128 v5, v[200:203] offset:6144
    ds_write_b128 v5, v[204:207] offset:7168
    s_waitcnt lgkmcnt(0)
    s_mov_b64 exec, 1
    ds_add_u32 v2, v3 offset:88
    s_mov_b64 exec, -1
bidle_131:
    s_endpgm
L_end:
    s_endpgm
.section .rodata,"a"
.p2align 6
.amdhsa_kernel sequential_preLN__linear_kernel_hedgehog__dense_activation_mish__prompt_kernel
  .amdhsa_next_free_vgpr 256
  .amdhsa_next_free_sgpr 102
  .amdhsa_accum_offset 256
  .amdhsa_group_segment_fixed_size 0
  .amdhsa_kernarg_size 88
  .amdhsa_user_sgpr_count 2
  .amdhsa_user_sgpr_kernarg_segment_ptr 1
  .amdhsa_system_sgpr_workgroup_id_x 1
  .amdhsa_float_denorm_mode_32 3
.end_amdhsa_kernel
```
